```python
import torch

def _softmax(x, axis=-1):
    return torch.softmax(x, dim=axis)
def _gelu(x):
    return torch.nn.functional.gelu(x, approximate="tanh")
def _silu(x):
    return torch.nn.functional.silu(x)
def _sigmoid(x):
    return torch.sigmoid(x)
def _layernorm(x, axis=-1, eps=1e-5):
    m = x.mean(dim=axis, keepdim=True)
    v = x.var(dim=axis, keepdim=True, unbiased=False)
    return (x - m) / torch.sqrt(v + eps)
def _scatter_add(tgt, idx, src, axis=0):
    return tgt.clone().index_add_(axis, idx, src)
def _segment_sum(src, seg, n):
    out = torch.zeros((n,) + src.shape[1:], dtype=src.dtype)
    return out.index_add_(0, seg, src)
def _pad(x, pw):
    flat = tuple(v for pair in reversed(pw) for v in pair)
    return torch.nn.functional.pad(x, flat)

kernel_name = 'standalone__gqa_softmax__near_ridge'

def setup_inputs():

    _w = (lambda a: (lambda t: t.to(torch.bfloat16) if t.is_floating_point() else t)(torch.as_tensor(a)))
    B, Hq, Hkv, Sq, Sk, D = 16, 32, 8, 96, 512, 128
    return {
        "q": _w((lambda *s: torch.randn(*s, dtype=torch.bfloat16) * 0.8)(B, Hq, Sq, D)),
        "k": _w((lambda *s: torch.randn(*s, dtype=torch.bfloat16) * 0.8)(B, Hkv, Sk, D)),
        "v": _w((lambda *s: torch.randn(*s, dtype=torch.bfloat16) * 0.05)(B, Hkv, Sk, D)),
    }

def reference(q, k, v):
    B, Hq, Sq, D = q.shape
    Hkv = k.shape[1]
    rep = Hq // Hkv
    k = (lambda x, n, axis: torch.repeat_interleave(x, n, dim=axis))(k, rep, axis=1)
    v = (lambda x, n, axis: torch.repeat_interleave(x, n, dim=axis))(v, rep, axis=1)
    scale = D ** -0.5
    scores = torch.einsum("bhqd,bhkd->bhqk", q, k) * scale
    p = _softmax(scores, axis=-1)
    return torch.einsum("bhqk,bhkd->bhqd", p, v)
```

```asm
; @launch grid=(256,1,1) block=(256,1,1) lds=163840
.amdgcn_target "amdgcn-amd-amdhsa--gfx950"
.text
.globl standalone__gqa_softmax__near_ridge_kernel
.p2align 12
.p2align 8
.type standalone__gqa_softmax__near_ridge_kernel,@function
standalone__gqa_softmax__near_ridge_kernel:
s_cmp_ge_u32 s2, 256
s_cbranch_scc1 L_end
s_getpc_b64 s[40:41]
L_pc:
s_lshr_b32 s42, s2, 3
s_mul_i32 s42, s42, 1
s_cmp_ge_u32 s42, 19
s_cselect_b32 s39, 19, 0
s_sub_u32 s42, s42, s39
s_cmp_ge_u32 s42, 19
s_cselect_b32 s39, 19, 0
s_sub_u32 s42, s42, s39
s_lshl_b32 s42, s42, 10
s_add_u32 s40, s40, s42
s_addc_u32 s41, s41, 0
v_lshlrev_b32 v126, 4, v0
v_cmp_gt_u32 vcc, 64, v0
s_and_saveexec_b64 s[92:93], vcc
s_cbranch_execz L_cpf_skip
global_load_dwordx4 v[120:123], v126, s[40:41] offset:0
L_cpf_skip:
s_mov_b64 exec, s[92:93]
s_load_dwordx4 s[4:7], s[0:1], 0
s_load_dwordx4 s[8:11], s[0:1], 16
v_lshrrev_b32 v30, 6, v0
v_and_b32 v0, 63, v0
v_readfirstlane_b32 s16, v30
s_and_b32 s14, s2, 7
s_lshr_b32 s15, s2, 4
s_lshl_b32 s15, s15, 3
s_or_b32 s14, s14, s15
s_bfe_u32 s15, s2, 0x10003
v_lshrrev_b32 v30, 4, v0
v_and_b32 v31, 15, v0
v_and_b32 v28, 2, v30
v_xor_b32 v28, v31, v28
v_lshlrev_b32 v28, 4, v28
v_lshl_add_u32 v3, v30, 10, v28
v_lshl_add_u32 v28, v30, 8, v28
v_add_u32 v68, 192, v28
v_add_u32 v69, 128, v28
v_add_u32 v70, 64, v28
v_add_u32 v71, 0, v28
v_and_b32 v29, 1, v30
v_lshlrev_b32 v29, 1, v29
v_xor_b32 v29, v31, v29
v_lshlrev_b32 v29, 4, v29
v_lshl_add_u32 v29, v30, 8, v29
v_add_u32 v72, 192, v29
v_add_u32 v73, 128, v29
v_add_u32 v74, 64, v29
v_add_u32 v75, 0, v29
s_lshl_b32 s45, s14, 2
s_lshl_b32 s46, s15, 1
s_add_u32 s45, s45, s46
s_mul_i32 s36, s45, 24576
s_mul_i32 s45, s16, 12288
s_add_u32 s36, s36, s45
s_lshl_b32 s37, s14, 17
s_lshl_b32 s45, s16, 12
s_add_u32 s37, s37, s45
s_mul_i32 s38, s16, 4352
s_waitcnt lgkmcnt(0)
s_mov_b32 s20, s4
s_mov_b32 s21, s5
s_mov_b32 s22, 12582912
s_mov_b32 s23, 0x20000
s_add_u32 m0, s38, 139264
s_add_u32 s47, s36, 0
buffer_load_dwordx4 v3, s[20:23], s47 offen offset:0 sc1 nt lds
s_add_u32 m0, s38, 140096
s_nop 0
buffer_load_dwordx4 v3, s[20:23], s47 offen offset:256 sc1 nt lds
s_add_u32 m0, s38, 140928
s_nop 0
buffer_load_dwordx4 v3, s[20:23], s47 offen offset:512 sc1 nt lds
s_add_u32 m0, s38, 141760
s_nop 0
buffer_load_dwordx4 v3, s[20:23], s47 offen offset:768 sc1 nt lds
s_sub_u32 s24, s6, 192
s_subb_u32 s25, s7, 0
s_mov_b32 s26, 16777408
s_mov_b32 s27, 0x20000
s_sub_u32 s28, s8, 192
s_subb_u32 s29, s9, 0
s_mov_b32 s30, 16777408
s_mov_b32 s31, 0x20000
s_add_u32 m0, s38, 0
s_add_u32 s54, s37, 0
buffer_load_dwordx4 v68, s[24:27], s54 offen offset:0 sc1 nt lds
buffer_load_dwordx4 v69, s[24:27], s54 offen offset:1088 sc1 nt lds
buffer_load_dwordx4 v70, s[24:27], s54 offen offset:2176 sc1 nt lds
buffer_load_dwordx4 v71, s[24:27], s54 offen offset:3264 sc1 nt lds
s_add_u32 m0, s38, 104448
s_add_u32 s47, s36, 4096
buffer_load_dwordx4 v3, s[20:23], s47 offen offset:0 sc1 nt lds
s_add_u32 m0, s38, 105280
s_nop 0
buffer_load_dwordx4 v3, s[20:23], s47 offen offset:256 sc1 nt lds
s_add_u32 m0, s38, 106112
s_nop 0
buffer_load_dwordx4 v3, s[20:23], s47 offen offset:512 sc1 nt lds
s_add_u32 m0, s38, 106944
s_nop 0
buffer_load_dwordx4 v3, s[20:23], s47 offen offset:768 sc1 nt lds
s_mov_b32 s32, s10
s_mov_b32 s33, s11
s_mov_b32 s34, 12582912
s_mov_b32 s35, 0x20000
v_and_b32 v28, 3, v0
v_mul_u32_u24 v28, 1088, v28
v_bfe_u32 v29, v0, 2, 2
v_lshl_add_u32 v28, v29, 8, v28
v_and_b32 v29, 2, v29
v_lshrrev_b32 v30, 4, v0
v_xor_b32 v29, v29, v30
v_lshl_add_u32 v4, v29, 4, v28
v_bfe_u32 v28, v0, 2, 2
v_mul_u32_u24 v28, 1088, v28
v_lshl_add_u32 v28, v30, 8, v28
v_and_b32 v29, 1, v30
v_lshl_add_u32 v28, v29, 5, v28
v_and_b32 v29, 3, v0
v_lshl_add_u32 v5, v29, 3, v28
v_xor_b32 v6, 32, v5
s_mov_b32 s43, 0x3e0293ee
s_mov_b32 s44, 0
s_mov_b32 s49, 0x49800000
v_mov_b32 v13, 0xff800000
v_mov_b32 v14, 0xff800000
v_mov_b32 v15, 0xff800000
v_mov_b32 v30, s43
s_add_u32 s48, s38, 104448
v_add_u32 v1, s48, v4
s_mov_b64 s[92:93], exec
s_mov_b64 exec, 0
s_cmp_eq_u32 s16, 0
s_cbranch_scc1 L_pg0
s_cmp_eq_u32 s16, 1
s_cbranch_scc1 L_pg1
s_cmp_eq_u32 s16, 2
s_cbranch_scc1 L_pg2
s_branch L_pg3
L_pg_done:
s_mov_b64 exec, s[92:93]
s_waitcnt vmcnt(8)
ds_read_b128 v[192:195], v1 offset:34816
ds_read_b128 v[196:199], v1 offset:34880
ds_read_b128 v[200:203], v1 offset:34944
ds_read_b128 v[204:207], v1 offset:35008
s_waitcnt lgkmcnt(0)
s_add_u32 m0, s38, 17408
s_add_u32 s54, s37, 0
buffer_load_dwordx4 v72, s[28:31], s54 offen offset:0 sc1 nt lds
buffer_load_dwordx4 v73, s[28:31], s54 offen offset:1088 sc1 nt lds
v_lshlrev_b32 v208, 16, v192
v_lshlrev_b32 v212, 16, v193
v_lshlrev_b32 v216, 16, v194
v_lshlrev_b32 v220, 16, v195
v_and_b32 v209, 0xffff0000, v192
v_and_b32 v213, 0xffff0000, v193
v_and_b32 v217, 0xffff0000, v194
v_and_b32 v221, 0xffff0000, v195
v_pk_mul_f32 v[208:209], v[208:209], v[30:31] op_sel_hi:[1,0]
v_pk_mul_f32 v[212:213], v[212:213], v[30:31] op_sel_hi:[1,0]
v_pk_mul_f32 v[216:217], v[216:217], v[30:31] op_sel_hi:[1,0]
v_pk_mul_f32 v[220:221], v[220:221], v[30:31] op_sel_hi:[1,0]
v_cvt_pk_bf16_f32 v210, v208, v209
v_cvt_pk_bf16_f32 v214, v212, v213
v_cvt_pk_bf16_f32 v218, v216, v217
v_cvt_pk_bf16_f32 v222, v220, v221
v_accvgpr_write_b32 a0, v210
v_accvgpr_write_b32 a1, v214
buffer_load_dwordx4 v74, s[28:31], s54 offen offset:2176 sc1 nt lds
v_accvgpr_write_b32 a2, v218
v_accvgpr_write_b32 a3, v222
v_lshlrev_b32 v208, 16, v196
v_lshlrev_b32 v212, 16, v197
v_lshlrev_b32 v216, 16, v198
v_lshlrev_b32 v220, 16, v199
v_and_b32 v209, 0xffff0000, v196
v_and_b32 v213, 0xffff0000, v197
v_and_b32 v217, 0xffff0000, v198
v_and_b32 v221, 0xffff0000, v199
v_pk_mul_f32 v[208:209], v[208:209], v[30:31] op_sel_hi:[1,0]
v_pk_mul_f32 v[212:213], v[212:213], v[30:31] op_sel_hi:[1,0]
v_pk_mul_f32 v[216:217], v[216:217], v[30:31] op_sel_hi:[1,0]
v_pk_mul_f32 v[220:221], v[220:221], v[30:31] op_sel_hi:[1,0]
v_cvt_pk_bf16_f32 v210, v208, v209
v_cvt_pk_bf16_f32 v214, v212, v213
v_cvt_pk_bf16_f32 v218, v216, v217
v_cvt_pk_bf16_f32 v222, v220, v221
buffer_load_dwordx4 v75, s[28:31], s54 offen offset:3264 sc1 nt lds
v_accvgpr_write_b32 a4, v210
v_accvgpr_write_b32 a5, v214
v_accvgpr_write_b32 a6, v218
v_accvgpr_write_b32 a7, v222
v_lshlrev_b32 v208, 16, v200
v_lshlrev_b32 v212, 16, v201
v_lshlrev_b32 v216, 16, v202
v_lshlrev_b32 v220, 16, v203
v_and_b32 v209, 0xffff0000, v200
v_and_b32 v213, 0xffff0000, v201
v_and_b32 v217, 0xffff0000, v202
v_and_b32 v221, 0xffff0000, v203
v_pk_mul_f32 v[208:209], v[208:209], v[30:31] op_sel_hi:[1,0]
v_pk_mul_f32 v[212:213], v[212:213], v[30:31] op_sel_hi:[1,0]
v_pk_mul_f32 v[216:217], v[216:217], v[30:31] op_sel_hi:[1,0]
v_pk_mul_f32 v[220:221], v[220:221], v[30:31] op_sel_hi:[1,0]
v_cvt_pk_bf16_f32 v210, v208, v209
v_cvt_pk_bf16_f32 v214, v212, v213
s_add_u32 m0, s38, 34816
s_add_u32 s54, s37, 16384
buffer_load_dwordx4 v68, s[24:27], s54 offen offset:0 sc1 nt lds
v_cvt_pk_bf16_f32 v218, v216, v217
v_cvt_pk_bf16_f32 v222, v220, v221
v_accvgpr_write_b32 a8, v210
v_accvgpr_write_b32 a9, v214
v_accvgpr_write_b32 a10, v218
v_accvgpr_write_b32 a11, v222
v_lshlrev_b32 v208, 16, v204
v_lshlrev_b32 v212, 16, v205
v_lshlrev_b32 v216, 16, v206
v_lshlrev_b32 v220, 16, v207
v_and_b32 v209, 0xffff0000, v204
v_and_b32 v213, 0xffff0000, v205
v_and_b32 v217, 0xffff0000, v206
v_and_b32 v221, 0xffff0000, v207
v_pk_mul_f32 v[208:209], v[208:209], v[30:31] op_sel_hi:[1,0]
v_pk_mul_f32 v[212:213], v[212:213], v[30:31] op_sel_hi:[1,0]
v_pk_mul_f32 v[216:217], v[216:217], v[30:31] op_sel_hi:[1,0]
v_pk_mul_f32 v[220:221], v[220:221], v[30:31] op_sel_hi:[1,0]
buffer_load_dwordx4 v69, s[24:27], s54 offen offset:1088 sc1 nt lds
v_cvt_pk_bf16_f32 v210, v208, v209
v_cvt_pk_bf16_f32 v214, v212, v213
v_cvt_pk_bf16_f32 v218, v216, v217
v_cvt_pk_bf16_f32 v222, v220, v221
v_accvgpr_write_b32 a12, v210
v_accvgpr_write_b32 a13, v214
v_accvgpr_write_b32 a14, v218
v_accvgpr_write_b32 a15, v222
v_mov_b32 v10, 0
v_mov_b32 v11, 0
v_mov_b32 v12, 0
v_mov_b32 v7, v4
v_mov_b32 v8, v5
v_mov_b32 v9, v6
s_waitcnt vmcnt(10)
s_barrier
ds_read_b128 a[48:51], v7 offset:0
ds_read_b128 a[52:55], v7 offset:64
ds_read_b128 a[56:59], v7 offset:128
ds_read_b128 a[60:63], v7 offset:192
ds_read_b128 a[64:67], v7 offset:4352
ds_read_b128 a[68:71], v7 offset:4416
ds_read_b128 a[72:75], v7 offset:4480
ds_read_b128 a[76:79], v7 offset:4544
ds_read_b128 a[80:83], v7 offset:8704
ds_read_b128 a[84:87], v7 offset:8768
ds_read_b128 a[88:91], v7 offset:8832
ds_read_b128 a[92:95], v7 offset:8896
ds_read_b128 a[96:99], v7 offset:13056
ds_read_b128 a[100:103], v7 offset:13120
ds_read_b128 a[104:107], v7 offset:13184
ds_read_b128 a[108:111], v7 offset:13248
buffer_load_dwordx4 v70, s[24:27], s54 offen offset:2176 sc1 nt lds
s_waitcnt lgkmcnt(8)
v_mfma_f32_16x16x32_bf16 v[32:35], a[48:51], a[0:3], 0
v_mfma_f32_16x16x32_bf16 v[32:35], a[52:55], a[4:7], v[32:35]
v_mfma_f32_16x16x32_bf16 v[32:35], a[56:59], a[8:11], v[32:35]
v_mfma_f32_16x16x32_bf16 v[32:35], a[60:63], a[12:15], v[32:35]
v_mfma_f32_16x16x32_bf16 v[36:39], a[64:67], a[0:3], 0
v_mfma_f32_16x16x32_bf16 v[36:39], a[68:71], a[4:7], v[36:39]
v_mfma_f32_16x16x32_bf16 v[36:39], a[72:75], a[8:11], v[36:39]
v_mfma_f32_16x16x32_bf16 v[36:39], a[76:79], a[12:15], v[36:39]
s_nop 7
buffer_load_dwordx4 v71, s[24:27], s54 offen offset:3264 sc1 nt lds
v_max3_f32 v28, v32, v33, v13
v_max3_f32 v29, v34, v35, v36
v_max3_f32 v28, v37, v38, v28
v_max3_f32 v28, v39, v29, v28
s_nop 0
v_mov_b32 v29, v28
s_nop 1
v_permlane16_swap_b32 v28, v29
s_nop 0
v_max_f32 v28, v28, v29
s_nop 0
v_mov_b32 v29, v28
s_nop 1
v_permlane32_swap_b32 v28, v29
s_nop 0
v_max_f32 v28, v28, v29
v_sub_f32 v32, v32, v28
v_sub_f32 v33, v33, v28
s_add_u32 m0, s38, 52224
s_add_u32 s54, s37, 16384
buffer_load_dwordx4 v72, s[28:31], s54 offen offset:0 sc1 nt lds
v_sub_f32 v34, v34, v28
v_sub_f32 v35, v35, v28
v_sub_f32 v36, v36, v28
v_sub_f32 v37, v37, v28
v_sub_f32 v38, v38, v28
v_sub_f32 v39, v39, v28
v_sub_f32 v16, 0, v28
v_sub_f32 v17, 0, v28
v_sub_f32 v18, 0, v28
v_sub_f32 v19, 0, v28
s_waitcnt lgkmcnt(0)
s_nop 1
v_mfma_f32_16x16x32_bf16 v[40:43], a[80:83], a[0:3], v[16:19]
v_exp_f32 v32, v32
v_mfma_f32_16x16x32_bf16 v[40:43], a[84:87], a[4:7], v[40:43]
v_exp_f32 v33, v33
v_add_f32 v10, v10, v32
v_mfma_f32_16x16x32_bf16 v[40:43], a[88:91], a[8:11], v[40:43]
v_exp_f32 v34, v34
v_mfma_f32_16x16x32_bf16 v[40:43], a[92:95], a[12:15], v[40:43]
v_add_f32 v10, v10, v33
v_cvt_pk_bf16_f32 v56, v32, v33
v_exp_f32 v35, v35
v_add_f32 v10, v10, v34
v_mfma_f32_16x16x32_bf16 v[44:47], a[96:99], a[0:3], v[16:19]
v_exp_f32 v36, v36
v_mfma_f32_16x16x32_bf16 v[44:47], a[100:103], a[4:7], v[44:47]
v_add_f32 v10, v10, v35
v_cvt_pk_bf16_f32 v57, v34, v35
v_exp_f32 v37, v37
v_add_f32 v10, v10, v36
v_mfma_f32_16x16x32_bf16 v[44:47], a[104:107], a[8:11], v[44:47]
v_exp_f32 v38, v38
v_mfma_f32_16x16x32_bf16 v[44:47], a[108:111], a[12:15], v[44:47]
v_add_f32 v10, v10, v37
v_cvt_pk_bf16_f32 v58, v36, v37
v_exp_f32 v39, v39
v_add_f32 v10, v10, v38
v_add_f32 v10, v10, v39
v_cvt_pk_bf16_f32 v59, v38, v39
s_waitcnt vmcnt(9)
ds_read_b128 v[192:195], v1 offset:0
ds_read_b128 v[196:199], v1 offset:64
ds_read_b128 v[200:203], v1 offset:128
ds_read_b128 v[204:207], v1 offset:192
v_exp_f32 v40, v40
v_exp_f32 v41, v41
v_add_f32 v10, v10, v40
v_exp_f32 v42, v42
v_add_f32 v10, v10, v41
v_cvt_pk_bf16_f32 v60, v40, v41
v_exp_f32 v43, v43
v_add_f32 v10, v10, v42
v_exp_f32 v44, v44
v_add_f32 v10, v10, v43
v_cvt_pk_bf16_f32 v61, v42, v43
v_exp_f32 v45, v45
v_add_f32 v10, v10, v44
v_exp_f32 v46, v46
v_add_f32 v10, v10, v45
v_cvt_pk_bf16_f32 v62, v44, v45
buffer_load_dwordx4 v73, s[28:31], s54 offen offset:1088 sc1 nt lds
v_exp_f32 v47, v47
v_add_f32 v10, v10, v46
v_add_f32 v10, v10, v47
v_cvt_pk_bf16_f32 v63, v46, v47
s_waitcnt lgkmcnt(0)
v_lshlrev_b32 v208, 16, v192
v_lshlrev_b32 v212, 16, v193
v_lshlrev_b32 v216, 16, v194
v_lshlrev_b32 v220, 16, v195
v_and_b32 v209, 0xffff0000, v192
v_and_b32 v213, 0xffff0000, v193
v_and_b32 v217, 0xffff0000, v194
v_and_b32 v221, 0xffff0000, v195
v_pk_mul_f32 v[208:209], v[208:209], v[30:31] op_sel_hi:[1,0]
v_pk_mul_f32 v[212:213], v[212:213], v[30:31] op_sel_hi:[1,0]
v_pk_mul_f32 v[216:217], v[216:217], v[30:31] op_sel_hi:[1,0]
v_pk_mul_f32 v[220:221], v[220:221], v[30:31] op_sel_hi:[1,0]
v_cvt_pk_bf16_f32 v210, v208, v209
v_cvt_pk_bf16_f32 v214, v212, v213
buffer_load_dwordx4 v74, s[28:31], s54 offen offset:2176 sc1 nt lds
v_cvt_pk_bf16_f32 v218, v216, v217
v_cvt_pk_bf16_f32 v222, v220, v221
v_accvgpr_write_b32 a16, v210
v_accvgpr_write_b32 a17, v214
v_accvgpr_write_b32 a18, v218
v_accvgpr_write_b32 a19, v222
v_lshlrev_b32 v208, 16, v196
v_lshlrev_b32 v212, 16, v197
v_lshlrev_b32 v216, 16, v198
v_lshlrev_b32 v220, 16, v199
v_and_b32 v209, 0xffff0000, v196
v_and_b32 v213, 0xffff0000, v197
v_and_b32 v217, 0xffff0000, v198
v_and_b32 v221, 0xffff0000, v199
v_pk_mul_f32 v[208:209], v[208:209], v[30:31] op_sel_hi:[1,0]
v_pk_mul_f32 v[212:213], v[212:213], v[30:31] op_sel_hi:[1,0]
v_pk_mul_f32 v[216:217], v[216:217], v[30:31] op_sel_hi:[1,0]
v_pk_mul_f32 v[220:221], v[220:221], v[30:31] op_sel_hi:[1,0]
buffer_load_dwordx4 v75, s[28:31], s54 offen offset:3264 sc1 nt lds
v_cvt_pk_bf16_f32 v210, v208, v209
v_cvt_pk_bf16_f32 v214, v212, v213
v_cvt_pk_bf16_f32 v218, v216, v217
v_cvt_pk_bf16_f32 v222, v220, v221
v_accvgpr_write_b32 a20, v210
v_accvgpr_write_b32 a21, v214
v_accvgpr_write_b32 a22, v218
v_accvgpr_write_b32 a23, v222
v_lshlrev_b32 v208, 16, v200
v_lshlrev_b32 v212, 16, v201
v_lshlrev_b32 v216, 16, v202
v_lshlrev_b32 v220, 16, v203
v_and_b32 v209, 0xffff0000, v200
v_and_b32 v213, 0xffff0000, v201
v_and_b32 v217, 0xffff0000, v202
v_and_b32 v221, 0xffff0000, v203
v_pk_mul_f32 v[208:209], v[208:209], v[30:31] op_sel_hi:[1,0]
v_pk_mul_f32 v[212:213], v[212:213], v[30:31] op_sel_hi:[1,0]
s_add_u32 m0, s38, 139264
s_add_u32 s47, s36, 8192
buffer_load_dwordx4 v3, s[20:23], s47 offen offset:0 sc1 nt lds
v_pk_mul_f32 v[216:217], v[216:217], v[30:31] op_sel_hi:[1,0]
v_pk_mul_f32 v[220:221], v[220:221], v[30:31] op_sel_hi:[1,0]
v_cvt_pk_bf16_f32 v210, v208, v209
v_cvt_pk_bf16_f32 v214, v212, v213
v_cvt_pk_bf16_f32 v218, v216, v217
v_cvt_pk_bf16_f32 v222, v220, v221
v_accvgpr_write_b32 a24, v210
v_accvgpr_write_b32 a25, v214
v_accvgpr_write_b32 a26, v218
v_accvgpr_write_b32 a27, v222
v_lshlrev_b32 v208, 16, v204
v_lshlrev_b32 v212, 16, v205
v_lshlrev_b32 v216, 16, v206
v_lshlrev_b32 v220, 16, v207
v_and_b32 v209, 0xffff0000, v204
v_and_b32 v213, 0xffff0000, v205
v_and_b32 v217, 0xffff0000, v206
v_and_b32 v221, 0xffff0000, v207
s_add_u32 m0, s38, 140096
s_nop 0
buffer_load_dwordx4 v3, s[20:23], s47 offen offset:256 sc1 nt lds
v_pk_mul_f32 v[208:209], v[208:209], v[30:31] op_sel_hi:[1,0]
v_pk_mul_f32 v[212:213], v[212:213], v[30:31] op_sel_hi:[1,0]
v_pk_mul_f32 v[216:217], v[216:217], v[30:31] op_sel_hi:[1,0]
v_pk_mul_f32 v[220:221], v[220:221], v[30:31] op_sel_hi:[1,0]
v_cvt_pk_bf16_f32 v210, v208, v209
v_cvt_pk_bf16_f32 v214, v212, v213
v_cvt_pk_bf16_f32 v218, v216, v217
v_cvt_pk_bf16_f32 v222, v220, v221
v_accvgpr_write_b32 a28, v210
v_accvgpr_write_b32 a29, v214
v_accvgpr_write_b32 a30, v218
v_accvgpr_write_b32 a31, v222
s_nop 1
v_mfma_f32_16x16x32_bf16 v[48:51], a[48:51], a[16:19], 0
v_mfma_f32_16x16x32_bf16 v[48:51], a[52:55], a[20:23], v[48:51]
v_mfma_f32_16x16x32_bf16 v[48:51], a[56:59], a[24:27], v[48:51]
v_mfma_f32_16x16x32_bf16 v[48:51], a[60:63], a[28:31], v[48:51]
v_mfma_f32_16x16x32_bf16 v[52:55], a[64:67], a[16:19], 0
v_mfma_f32_16x16x32_bf16 v[52:55], a[68:71], a[20:23], v[52:55]
v_mfma_f32_16x16x32_bf16 v[52:55], a[72:75], a[24:27], v[52:55]
v_mfma_f32_16x16x32_bf16 v[52:55], a[76:79], a[28:31], v[52:55]
s_waitcnt vmcnt(10)
s_barrier
s_add_u32 m0, s38, 140928
s_nop 0
buffer_load_dwordx4 v3, s[20:23], s47 offen offset:512 sc1 nt lds
ds_read_b64_tr_b16 a[112:113], v8 offset:17408
ds_read_b64_tr_b16 a[114:115], v8 offset:21760
ds_read_b64_tr_b16 a[116:117], v9 offset:17408
ds_read_b64_tr_b16 a[118:119], v9 offset:21760
ds_read_b64_tr_b16 a[120:121], v8 offset:17472
ds_read_b64_tr_b16 a[122:123], v8 offset:21824
ds_read_b64_tr_b16 a[124:125], v9 offset:17472
ds_read_b64_tr_b16 a[126:127], v9 offset:21824
ds_read_b64_tr_b16 a[128:129], v8 offset:17536
ds_read_b64_tr_b16 a[130:131], v8 offset:21888
ds_read_b64_tr_b16 a[132:133], v9 offset:17536
ds_read_b64_tr_b16 a[134:135], v9 offset:21888
ds_read_b64_tr_b16 a[136:137], v8 offset:17600
ds_read_b64_tr_b16 a[138:139], v8 offset:21952
ds_read_b64_tr_b16 a[140:141], v9 offset:17600
ds_read_b64_tr_b16 a[142:143], v9 offset:21952
s_nop 1
v_max3_f32 v28, v48, v49, v14
v_max3_f32 v29, v50, v51, v52
v_max3_f32 v28, v53, v54, v28
v_max3_f32 v28, v55, v29, v28
s_nop 0
v_mov_b32 v29, v28
s_nop 1
v_permlane16_swap_b32 v28, v29
s_nop 0
v_max_f32 v28, v28, v29
s_nop 0
v_mov_b32 v29, v28
s_nop 1
v_permlane32_swap_b32 v28, v29
s_nop 0
v_max_f32 v28, v28, v29
v_sub_f32 v48, v48, v28
s_add_u32 m0, s38, 141760
s_nop 0
buffer_load_dwordx4 v3, s[20:23], s47 offen offset:768 sc1 nt lds
v_sub_f32 v49, v49, v28
v_sub_f32 v50, v50, v28
v_sub_f32 v51, v51, v28
v_sub_f32 v52, v52, v28
v_sub_f32 v53, v53, v28
v_sub_f32 v54, v54, v28
v_sub_f32 v55, v55, v28
v_sub_f32 v20, 0, v28
v_sub_f32 v21, 0, v28
v_sub_f32 v22, 0, v28
v_sub_f32 v23, 0, v28
ds_read_b64_tr_b16 a[144:145], v8 offset:26112
ds_read_b64_tr_b16 a[146:147], v8 offset:30464
ds_read_b64_tr_b16 a[148:149], v9 offset:26112
ds_read_b64_tr_b16 a[150:151], v9 offset:30464
ds_read_b64_tr_b16 a[152:153], v8 offset:26176
ds_read_b64_tr_b16 a[154:155], v8 offset:30528
ds_read_b64_tr_b16 a[156:157], v9 offset:26176
ds_read_b64_tr_b16 a[158:159], v9 offset:30528
ds_read_b64_tr_b16 a[160:161], v8 offset:26240
ds_read_b64_tr_b16 a[162:163], v8 offset:30592
ds_read_b64_tr_b16 a[164:165], v9 offset:26240
ds_read_b64_tr_b16 a[166:167], v9 offset:30592
ds_read_b64_tr_b16 a[168:169], v8 offset:26304
L_pg0:
s_cbranch_execz L_pg_done
ds_read_b64_tr_b16 a[170:171], v8 offset:30656
ds_read_b64_tr_b16 a[172:173], v9 offset:26304
ds_read_b64_tr_b16 a[174:175], v9 offset:30656
s_nop 1
v_mfma_f32_16x16x32_bf16 v[32:35], a[80:83], a[16:19], v[20:23]
v_exp_f32 v48, v48
v_mfma_f32_16x16x32_bf16 v[32:35], a[84:87], a[20:23], v[32:35]
s_add_u32 m0, s38, 69632
s_add_u32 s54, s37, 32768
v_mfma_f32_16x16x32_bf16 v[32:35], a[88:91], a[24:27], v[32:35]
v_exp_f32 v49, v49
v_mfma_f32_16x16x32_bf16 v[32:35], a[92:95], a[28:31], v[32:35]
buffer_load_dwordx4 v68, s[24:27], s54 offen offset:0 sc1 nt lds
v_add_f32 v11, v11, v48
v_mfma_f32_16x16x32_bf16 v[36:39], a[96:99], a[16:19], v[20:23]
v_exp_f32 v50, v50
v_mfma_f32_16x16x32_bf16 v[36:39], a[100:103], a[20:23], v[36:39]
v_add_f32 v11, v11, v49
v_cvt_pk_bf16_f32 v64, v48, v49
v_mfma_f32_16x16x32_bf16 v[36:39], a[104:107], a[24:27], v[36:39]
v_exp_f32 v51, v51
v_mfma_f32_16x16x32_bf16 v[36:39], a[108:111], a[28:31], v[36:39]
v_add_f32 v11, v11, v50
s_waitcnt lgkmcnt(15)
v_mfma_f32_16x16x32_bf16 v[128:131], a[112:115], v[56:59], 0
v_exp_f32 v52, v52
v_mfma_f32_16x16x32_bf16 v[132:135], a[116:119], v[56:59], 0
buffer_load_dwordx4 v69, s[24:27], s54 offen offset:1088 sc1 nt lds
v_add_f32 v11, v11, v51
v_cvt_pk_bf16_f32 v65, v50, v51
v_mfma_f32_16x16x32_bf16 v[136:139], a[120:123], v[56:59], 0
v_exp_f32 v53, v53
v_mfma_f32_16x16x32_bf16 v[140:143], a[124:127], v[56:59], 0
v_add_f32 v11, v11, v52
v_mfma_f32_16x16x32_bf16 v[144:147], a[128:131], v[56:59], 0
v_exp_f32 v54, v54
v_mfma_f32_16x16x32_bf16 v[148:151], a[132:135], v[56:59], 0
v_add_f32 v11, v11, v53
v_cvt_pk_bf16_f32 v66, v52, v53
v_mfma_f32_16x16x32_bf16 v[152:155], a[136:139], v[56:59], 0
v_exp_f32 v55, v55
v_mfma_f32_16x16x32_bf16 v[156:159], a[140:143], v[56:59], 0
v_add_f32 v11, v11, v54
s_waitcnt vmcnt(10)
s_waitcnt lgkmcnt(0)
s_barrier
v_mfma_f32_16x16x32_bf16 v[128:131], a[144:147], v[60:63], v[128:131]
v_exp_f32 v32, v32
v_mfma_f32_16x16x32_bf16 v[132:135], a[148:151], v[60:63], v[132:135]
ds_read_b128 a[176:179], v7 offset:34816
ds_read_b128 a[180:183], v7 offset:34880
ds_read_b128 a[184:187], v7 offset:34944
v_add_f32 v11, v11, v55
v_cvt_pk_bf16_f32 v67, v54, v55
v_mfma_f32_16x16x32_bf16 v[136:139], a[152:155], v[60:63], v[136:139]
v_exp_f32 v33, v33
v_mfma_f32_16x16x32_bf16 v[140:143], a[156:159], v[60:63], v[140:143]
buffer_load_dwordx4 v70, s[24:27], s54 offen offset:2176 sc1 nt lds
ds_read_b128 a[188:191], v7 offset:35008
ds_read_b128 a[192:195], v7 offset:39168
ds_read_b128 a[196:199], v7 offset:39232
v_add_f32 v11, v11, v32
v_mfma_f32_16x16x32_bf16 v[144:147], a[160:163], v[60:63], v[144:147]
v_exp_f32 v34, v34
v_mfma_f32_16x16x32_bf16 v[148:151], a[164:167], v[60:63], v[148:151]
ds_read_b128 a[200:203], v7 offset:39296
ds_read_b128 a[204:207], v7 offset:39360
v_add_f32 v11, v11, v33
v_cvt_pk_bf16_f32 v56, v32, v33
v_mfma_f32_16x16x32_bf16 v[152:155], a[168:171], v[60:63], v[152:155]
v_exp_f32 v35, v35
v_mfma_f32_16x16x32_bf16 v[156:159], a[172:175], v[60:63], v[156:159]
v_add_f32 v11, v11, v34
s_waitcnt lgkmcnt(0)
v_mfma_f32_16x16x32_bf16 v[40:43], a[176:179], a[0:3], v[16:19]
v_exp_f32 v36, v36
v_mfma_f32_16x16x32_bf16 v[40:43], a[180:183], a[4:7], v[40:43]
buffer_load_dwordx4 v71, s[24:27], s54 offen offset:3264 sc1 nt lds
ds_read_b128 a[208:211], v7 offset:43520
ds_read_b128 a[212:215], v7 offset:43584
v_add_f32 v11, v11, v35
v_cvt_pk_bf16_f32 v57, v34, v35
v_mfma_f32_16x16x32_bf16 v[40:43], a[184:187], a[8:11], v[40:43]
v_exp_f32 v37, v37
v_mfma_f32_16x16x32_bf16 v[40:43], a[188:191], a[12:15], v[40:43]
ds_read_b128 a[216:219], v7 offset:43648
ds_read_b128 a[220:223], v7 offset:43712
v_add_f32 v11, v11, v36
v_mfma_f32_16x16x32_bf16 v[44:47], a[192:195], a[0:3], v[16:19]
v_exp_f32 v38, v38
v_mfma_f32_16x16x32_bf16 v[44:47], a[196:199], a[4:7], v[44:47]
ds_read_b128 a[224:227], v7 offset:47872
ds_read_b128 a[228:231], v7 offset:47936
v_add_f32 v11, v11, v37
v_cvt_pk_bf16_f32 v58, v36, v37
s_add_u32 m0, s38, 87040
s_add_u32 s54, s37, 32768
v_mfma_f32_16x16x32_bf16 v[44:47], a[200:203], a[8:11], v[44:47]
v_exp_f32 v39, v39
v_mfma_f32_16x16x32_bf16 v[44:47], a[204:207], a[12:15], v[44:47]
buffer_load_dwordx4 v72, s[28:31], s54 offen offset:0 sc1 nt lds
ds_read_b128 a[232:235], v7 offset:48000
ds_read_b128 a[236:239], v7 offset:48064
v_add_f32 v11, v11, v38
s_waitcnt lgkmcnt(0)
v_mfma_f32_16x16x32_bf16 v[48:51], a[208:211], a[0:3], v[16:19]
v_exp_f32 v40, v40
v_mfma_f32_16x16x32_bf16 v[48:51], a[212:215], a[4:7], v[48:51]
v_add_f32 v11, v11, v39
v_cvt_pk_bf16_f32 v59, v38, v39
v_mfma_f32_16x16x32_bf16 v[48:51], a[216:219], a[8:11], v[48:51]
v_exp_f32 v41, v41
v_mfma_f32_16x16x32_bf16 v[48:51], a[220:223], a[12:15], v[48:51]
buffer_load_dwordx4 v73, s[28:31], s54 offen offset:1088 sc1 nt lds
v_add_f32 v10, v10, v40
v_mfma_f32_16x16x32_bf16 v[52:55], a[224:227], a[0:3], v[16:19]
v_exp_f32 v42, v42
v_mfma_f32_16x16x32_bf16 v[52:55], a[228:231], a[4:7], v[52:55]
v_add_f32 v10, v10, v41
v_cvt_pk_bf16_f32 v60, v40, v41
v_mfma_f32_16x16x32_bf16 v[52:55], a[232:235], a[8:11], v[52:55]
v_exp_f32 v43, v43
v_mfma_f32_16x16x32_bf16 v[52:55], a[236:239], a[12:15], v[52:55]
v_add_f32 v10, v10, v42
v_mfma_f32_16x16x32_bf16 v[160:163], a[112:115], v[64:67], 0
v_exp_f32 v44, v44
v_mfma_f32_16x16x32_bf16 v[164:167], a[116:119], v[64:67], 0
buffer_load_dwordx4 v74, s[28:31], s54 offen offset:2176 sc1 nt lds
v_add_f32 v10, v10, v43
v_cvt_pk_bf16_f32 v61, v42, v43
v_mfma_f32_16x16x32_bf16 v[168:171], a[120:123], v[64:67], 0
v_exp_f32 v45, v45
v_mfma_f32_16x16x32_bf16 v[172:175], a[124:127], v[64:67], 0
v_add_f32 v10, v10, v44
v_mfma_f32_16x16x32_bf16 v[176:179], a[128:131], v[64:67], 0
v_exp_f32 v46, v46
v_mfma_f32_16x16x32_bf16 v[180:183], a[132:135], v[64:67], 0
v_add_f32 v10, v10, v45
v_cvt_pk_bf16_f32 v62, v44, v45
v_mfma_f32_16x16x32_bf16 v[184:187], a[136:139], v[64:67], 0
v_exp_f32 v47, v47
v_mfma_f32_16x16x32_bf16 v[188:191], a[140:143], v[64:67], 0
buffer_load_dwordx4 v75, s[28:31], s54 offen offset:3264 sc1 nt lds
v_add_f32 v10, v10, v46
s_waitcnt vmcnt(12)
s_barrier
v_mfma_f32_16x16x32_bf16 v[32:35], a[176:179], a[16:19], v[20:23]
v_exp_f32 v48, v48
v_mfma_f32_16x16x32_bf16 v[32:35], a[180:183], a[20:23], v[32:35]
ds_read_b64_tr_b16 v[224:225], v8 offset:52224
ds_read_b64_tr_b16 v[226:227], v8 offset:56576
v_add_f32 v10, v10, v47
v_cvt_pk_bf16_f32 v63, v46, v47
v_mfma_f32_16x16x32_bf16 v[32:35], a[184:187], a[24:27], v[32:35]
v_exp_f32 v49, v49
v_mfma_f32_16x16x32_bf16 v[32:35], a[188:191], a[28:31], v[32:35]
ds_read_b64_tr_b16 v[228:229], v9 offset:52224
ds_read_b64_tr_b16 v[230:231], v9 offset:56576
v_add_f32 v10, v10, v48
s_add_u32 m0, s38, 104448
s_add_u32 s54, s37, 49152
v_mfma_f32_16x16x32_bf16 v[36:39], a[192:195], a[16:19], v[20:23]
v_exp_f32 v50, v50
v_mfma_f32_16x16x32_bf16 v[36:39], a[196:199], a[20:23], v[36:39]
buffer_load_dwordx4 v68, s[24:27], s54 offen offset:0 sc1 nt lds
ds_read_b64_tr_b16 v[232:233], v8 offset:52288
ds_read_b64_tr_b16 v[234:235], v8 offset:56640
v_add_f32 v10, v10, v49
v_cvt_pk_bf16_f32 v64, v48, v49
v_mfma_f32_16x16x32_bf16 v[36:39], a[200:203], a[24:27], v[36:39]
v_exp_f32 v51, v51
v_mfma_f32_16x16x32_bf16 v[36:39], a[204:207], a[28:31], v[36:39]
ds_read_b64_tr_b16 v[236:237], v9 offset:52288
ds_read_b64_tr_b16 v[238:239], v9 offset:56640
v_add_f32 v10, v10, v50
v_mfma_f32_16x16x32_bf16 v[160:163], a[144:147], v[56:59], v[160:163]
v_exp_f32 v52, v52
v_mfma_f32_16x16x32_bf16 v[164:167], a[148:151], v[56:59], v[164:167]
ds_read_b64_tr_b16 v[240:241], v8 offset:52352
ds_read_b64_tr_b16 v[242:243], v8 offset:56704
v_add_f32 v10, v10, v51
v_cvt_pk_bf16_f32 v65, v50, v51
v_mfma_f32_16x16x32_bf16 v[168:171], a[152:155], v[56:59], v[168:171]
v_exp_f32 v53, v53
v_mfma_f32_16x16x32_bf16 v[172:175], a[156:159], v[56:59], v[172:175]
ds_read_b64_tr_b16 v[244:245], v9 offset:52352
ds_read_b64_tr_b16 v[246:247], v9 offset:56704
v_add_f32 v10, v10, v52
v_mfma_f32_16x16x32_bf16 v[176:179], a[160:163], v[56:59], v[176:179]
v_exp_f32 v54, v54
v_mfma_f32_16x16x32_bf16 v[180:183], a[164:167], v[56:59], v[180:183]
buffer_load_dwordx4 v69, s[24:27], s54 offen offset:1088 sc1 nt lds
ds_read_b64_tr_b16 v[248:249], v8 offset:52416
ds_read_b64_tr_b16 v[250:251], v8 offset:56768
v_add_f32 v10, v10, v53
v_cvt_pk_bf16_f32 v66, v52, v53
v_mfma_f32_16x16x32_bf16 v[184:187], a[168:171], v[56:59], v[184:187]
v_exp_f32 v55, v55
v_mfma_f32_16x16x32_bf16 v[188:191], a[172:175], v[56:59], v[188:191]
ds_read_b64_tr_b16 v[252:253], v9 offset:52416
ds_read_b64_tr_b16 v[254:255], v9 offset:56768
v_add_f32 v10, v10, v54
v_mfma_f32_16x16x32_bf16 v[40:43], a[208:211], a[16:19], v[20:23]
v_exp_f32 v32, v32
v_mfma_f32_16x16x32_bf16 v[40:43], a[212:215], a[20:23], v[40:43]
ds_read_b64_tr_b16 v[96:97], v8 offset:60928
ds_read_b64_tr_b16 v[98:99], v8 offset:65280
v_add_f32 v10, v10, v55
v_cvt_pk_bf16_f32 v67, v54, v55
v_mfma_f32_16x16x32_bf16 v[40:43], a[216:219], a[24:27], v[40:43]
v_exp_f32 v33, v33
v_mfma_f32_16x16x32_bf16 v[40:43], a[220:223], a[28:31], v[40:43]
ds_read_b64_tr_b16 v[100:101], v9 offset:60928
ds_read_b64_tr_b16 v[102:103], v9 offset:65280
v_add_f32 v11, v11, v32
v_mfma_f32_16x16x32_bf16 v[44:47], a[224:227], a[16:19], v[20:23]
v_exp_f32 v34, v34
v_mfma_f32_16x16x32_bf16 v[44:47], a[228:231], a[20:23], v[44:47]
buffer_load_dwordx4 v70, s[24:27], s54 offen offset:2176 sc1 nt lds
ds_read_b64_tr_b16 v[104:105], v8 offset:60992
ds_read_b64_tr_b16 v[106:107], v8 offset:65344
v_add_f32 v11, v11, v33
v_cvt_pk_bf16_f32 v56, v32, v33
v_mfma_f32_16x16x32_bf16 v[44:47], a[232:235], a[24:27], v[44:47]
v_exp_f32 v35, v35
v_mfma_f32_16x16x32_bf16 v[44:47], a[236:239], a[28:31], v[44:47]
ds_read_b64_tr_b16 v[108:109], v9 offset:60992
ds_read_b64_tr_b16 v[110:111], v9 offset:65344
v_add_f32 v11, v11, v34
s_waitcnt lgkmcnt(8)
v_mfma_f32_16x16x32_bf16 v[128:131], v[224:227], v[60:63], v[128:131]
v_exp_f32 v36, v36
v_mfma_f32_16x16x32_bf16 v[132:135], v[228:231], v[60:63], v[132:135]
ds_read_b64_tr_b16 v[112:113], v8 offset:61056
ds_read_b64_tr_b16 v[114:115], v8 offset:65408
v_add_f32 v11, v11, v35
v_cvt_pk_bf16_f32 v57, v34, v35
v_mfma_f32_16x16x32_bf16 v[136:139], v[232:235], v[60:63], v[136:139]
v_exp_f32 v37, v37
v_mfma_f32_16x16x32_bf16 v[140:143], v[236:239], v[60:63], v[140:143]
ds_read_b64_tr_b16 v[116:117], v9 offset:61056
ds_read_b64_tr_b16 v[118:119], v9 offset:65408
v_add_f32 v11, v11, v36
v_mfma_f32_16x16x32_bf16 v[144:147], v[240:243], v[60:63], v[144:147]
v_exp_f32 v38, v38
v_mfma_f32_16x16x32_bf16 v[148:151], v[244:247], v[60:63], v[148:151]
buffer_load_dwordx4 v71, s[24:27], s54 offen offset:3264 sc1 nt lds
ds_read_b64_tr_b16 v[120:121], v8 offset:61120
ds_read_b64_tr_b16 v[122:123], v8 offset:65472
v_add_f32 v11, v11, v37
v_cvt_pk_bf16_f32 v58, v36, v37
v_mfma_f32_16x16x32_bf16 v[152:155], v[248:251], v[60:63], v[152:155]
v_exp_f32 v39, v39
v_mfma_f32_16x16x32_bf16 v[156:159], v[252:255], v[60:63], v[156:159]
ds_read_b64_tr_b16 v[124:125], v9 offset:61120
ds_read_b64_tr_b16 v[126:127], v9 offset:65472
v_add_f32 v11, v11, v38
s_waitcnt vmcnt(12)
ds_read_b128 v[192:195], v1 offset:34816
ds_read_b128 v[196:199], v1 offset:34880
ds_read_b128 v[200:203], v1 offset:34944
ds_read_b128 v[204:207], v1 offset:35008
v_add_f32 v11, v11, v39
v_cvt_pk_bf16_f32 v59, v38, v39
s_nop 1
s_waitcnt lgkmcnt(4)
v_mfma_f32_16x16x32_bf16 v[128:131], v[96:99], v[64:67], v[128:131]
v_exp_f32 v40, v40
v_mfma_f32_16x16x32_bf16 v[132:135], v[100:103], v[64:67], v[132:135]
v_exp_f32 v41, v41
v_add_f32 v11, v11, v40
s_add_u32 m0, s38, 121856
s_add_u32 s54, s37, 49152
v_mfma_f32_16x16x32_bf16 v[136:139], v[104:107], v[64:67], v[136:139]
v_exp_f32 v42, v42
v_mfma_f32_16x16x32_bf16 v[140:143], v[108:111], v[64:67], v[140:143]
buffer_load_dwordx4 v72, s[28:31], s54 offen offset:0 sc1 nt lds
v_add_f32 v11, v11, v41
v_cvt_pk_bf16_f32 v60, v40, v41
v_exp_f32 v43, v43
v_add_f32 v11, v11, v42
v_mfma_f32_16x16x32_bf16 v[144:147], v[112:115], v[64:67], v[144:147]
v_exp_f32 v44, v44
v_mfma_f32_16x16x32_bf16 v[148:151], v[116:119], v[64:67], v[148:151]
v_add_f32 v11, v11, v43
v_cvt_pk_bf16_f32 v61, v42, v43
v_exp_f32 v45, v45
v_add_f32 v11, v11, v44
v_mfma_f32_16x16x32_bf16 v[152:155], v[120:123], v[64:67], v[152:155]
v_exp_f32 v46, v46
v_mfma_f32_16x16x32_bf16 v[156:159], v[124:127], v[64:67], v[156:159]
buffer_load_dwordx4 v73, s[28:31], s54 offen offset:1088 sc1 nt lds
v_add_f32 v11, v11, v45
v_cvt_pk_bf16_f32 v62, v44, v45
v_exp_f32 v47, v47
v_add_f32 v11, v11, v46
v_add_f32 v11, v11, v47
v_cvt_pk_bf16_f32 v63, v46, v47
s_waitcnt lgkmcnt(0)
v_mfma_f32_16x16x32_bf16 v[160:163], v[224:227], v[56:59], v[160:163]
v_lshlrev_b32 v208, 16, v192
v_lshlrev_b32 v212, 16, v193
v_lshlrev_b32 v216, 16, v194
v_lshlrev_b32 v220, 16, v195
v_and_b32 v209, 0xffff0000, v192
v_and_b32 v213, 0xffff0000, v193
v_and_b32 v217, 0xffff0000, v194
v_and_b32 v221, 0xffff0000, v195
v_mul_f32 v208, s43, v208
v_mul_f32 v212, s43, v212
v_mul_f32 v216, s43, v216
v_mul_f32 v220, s43, v220
v_mfma_f32_16x16x32_bf16 v[164:167], v[228:231], v[56:59], v[164:167]
v_mul_f32 v209, s43, v209
v_mul_f32 v213, s43, v213
v_mul_f32 v217, s43, v217
v_mul_f32 v221, s43, v221
v_cvt_pk_bf16_f32 v210, v208, v209
v_cvt_pk_bf16_f32 v214, v212, v213
v_cvt_pk_bf16_f32 v218, v216, v217
v_cvt_pk_bf16_f32 v222, v220, v221
v_accvgpr_write_b32 a32, v210
v_accvgpr_write_b32 a33, v214
v_accvgpr_write_b32 a34, v218
v_accvgpr_write_b32 a35, v222
v_mfma_f32_16x16x32_bf16 v[168:171], v[232:235], v[56:59], v[168:171]
v_lshlrev_b32 v208, 16, v196
v_lshlrev_b32 v212, 16, v197
v_lshlrev_b32 v216, 16, v198
v_lshlrev_b32 v220, 16, v199
v_and_b32 v209, 0xffff0000, v196
v_and_b32 v213, 0xffff0000, v197
v_and_b32 v217, 0xffff0000, v198
v_and_b32 v221, 0xffff0000, v199
v_mul_f32 v208, s43, v208
v_mul_f32 v212, s43, v212
v_mul_f32 v216, s43, v216
v_mul_f32 v220, s43, v220
v_mfma_f32_16x16x32_bf16 v[172:175], v[236:239], v[56:59], v[172:175]
v_mul_f32 v209, s43, v209
v_mul_f32 v213, s43, v213
v_mul_f32 v217, s43, v217
v_mul_f32 v221, s43, v221
v_cvt_pk_bf16_f32 v210, v208, v209
v_cvt_pk_bf16_f32 v214, v212, v213
v_cvt_pk_bf16_f32 v218, v216, v217
v_cvt_pk_bf16_f32 v222, v220, v221
v_accvgpr_write_b32 a36, v210
v_accvgpr_write_b32 a37, v214
v_accvgpr_write_b32 a38, v218
v_accvgpr_write_b32 a39, v222
v_mfma_f32_16x16x32_bf16 v[176:179], v[240:243], v[56:59], v[176:179]
v_lshlrev_b32 v208, 16, v200
v_lshlrev_b32 v212, 16, v201
v_lshlrev_b32 v216, 16, v202
v_lshlrev_b32 v220, 16, v203
v_and_b32 v209, 0xffff0000, v200
v_and_b32 v213, 0xffff0000, v201
v_and_b32 v217, 0xffff0000, v202
v_and_b32 v221, 0xffff0000, v203
v_mul_f32 v208, s43, v208
v_mul_f32 v212, s43, v212
v_mul_f32 v216, s43, v216
v_mul_f32 v220, s43, v220
v_mfma_f32_16x16x32_bf16 v[180:183], v[244:247], v[56:59], v[180:183]
v_mul_f32 v209, s43, v209
v_mul_f32 v213, s43, v213
v_mul_f32 v217, s43, v217
v_mul_f32 v221, s43, v221
v_cvt_pk_bf16_f32 v210, v208, v209
v_cvt_pk_bf16_f32 v214, v212, v213
v_cvt_pk_bf16_f32 v218, v216, v217
v_cvt_pk_bf16_f32 v222, v220, v221
v_accvgpr_write_b32 a40, v210
v_accvgpr_write_b32 a41, v214
v_accvgpr_write_b32 a42, v218
v_accvgpr_write_b32 a43, v222
v_mfma_f32_16x16x32_bf16 v[184:187], v[248:251], v[56:59], v[184:187]
v_lshlrev_b32 v208, 16, v204
v_lshlrev_b32 v212, 16, v205
v_lshlrev_b32 v216, 16, v206
v_lshlrev_b32 v220, 16, v207
v_and_b32 v209, 0xffff0000, v204
v_and_b32 v213, 0xffff0000, v205
v_and_b32 v217, 0xffff0000, v206
v_and_b32 v221, 0xffff0000, v207
v_mul_f32 v208, s43, v208
v_mul_f32 v212, s43, v212
v_mul_f32 v216, s43, v216
v_mul_f32 v220, s43, v220
v_mfma_f32_16x16x32_bf16 v[188:191], v[252:255], v[56:59], v[188:191]
v_mul_f32 v209, s43, v209
v_mul_f32 v213, s43, v213
v_mul_f32 v217, s43, v217
v_mul_f32 v221, s43, v221
v_cvt_pk_bf16_f32 v210, v208, v209
v_cvt_pk_bf16_f32 v214, v212, v213
v_cvt_pk_bf16_f32 v218, v216, v217
v_cvt_pk_bf16_f32 v222, v220, v221
v_accvgpr_write_b32 a44, v210
v_accvgpr_write_b32 a45, v214
v_accvgpr_write_b32 a46, v218
v_accvgpr_write_b32 a47, v222
s_nop 1
v_mfma_f32_16x16x32_bf16 v[48:51], a[48:51], a[32:35], 0
v_mfma_f32_16x16x32_bf16 v[48:51], a[52:55], a[36:39], v[48:51]
v_mfma_f32_16x16x32_bf16 v[48:51], a[56:59], a[40:43], v[48:51]
v_mfma_f32_16x16x32_bf16 v[48:51], a[60:63], a[44:47], v[48:51]
v_mfma_f32_16x16x32_bf16 v[52:55], a[64:67], a[32:35], 0
v_mfma_f32_16x16x32_bf16 v[52:55], a[68:71], a[36:39], v[52:55]
v_mfma_f32_16x16x32_bf16 v[52:55], a[72:75], a[40:43], v[52:55]
v_mfma_f32_16x16x32_bf16 v[52:55], a[76:79], a[44:47], v[52:55]
v_mfma_f32_16x16x32_bf16 v[160:163], v[96:99], v[60:63], v[160:163]
v_mfma_f32_16x16x32_bf16 v[164:167], v[100:103], v[60:63], v[164:167]
v_mfma_f32_16x16x32_bf16 v[168:171], v[104:107], v[60:63], v[168:171]
v_mfma_f32_16x16x32_bf16 v[172:175], v[108:111], v[60:63], v[172:175]
v_mfma_f32_16x16x32_bf16 v[176:179], v[112:115], v[60:63], v[176:179]
v_mfma_f32_16x16x32_bf16 v[180:183], v[116:119], v[60:63], v[180:183]
v_mfma_f32_16x16x32_bf16 v[184:187], v[120:123], v[60:63], v[184:187]
v_mfma_f32_16x16x32_bf16 v[188:191], v[124:127], v[60:63], v[188:191]
buffer_load_dwordx4 v74, s[28:31], s54 offen offset:2176 sc1 nt lds
v_max3_f32 v28, v48, v49, v15
v_max3_f32 v29, v50, v51, v52
v_max3_f32 v28, v53, v54, v28
v_max3_f32 v28, v55, v29, v28
s_nop 0
v_mov_b32 v29, v28
s_nop 1
v_permlane16_swap_b32 v28, v29
s_nop 0
v_max_f32 v28, v28, v29
s_nop 0
v_mov_b32 v29, v28
s_nop 1
v_permlane32_swap_b32 v28, v29
s_nop 0
v_max_f32 v28, v28, v29
v_sub_f32 v48, v48, v28
v_sub_f32 v49, v49, v28
buffer_load_dwordx4 v75, s[28:31], s54 offen offset:3264 sc1 nt lds
v_sub_f32 v50, v50, v28
v_sub_f32 v51, v51, v28
v_sub_f32 v52, v52, v28
v_sub_f32 v53, v53, v28
v_sub_f32 v54, v54, v28
v_sub_f32 v55, v55, v28
v_sub_f32 v24, 0, v28
v_sub_f32 v25, 0, v28
v_sub_f32 v26, 0, v28
v_sub_f32 v27, 0, v28
s_nop 1
v_mfma_f32_16x16x32_bf16 v[32:35], a[80:83], a[32:35], v[24:27]
v_exp_f32 v48, v48
v_mfma_f32_16x16x32_bf16 v[32:35], a[84:87], a[36:39], v[32:35]
v_exp_f32 v49, v49
v_add_f32 v12, v12, v48
v_mfma_f32_16x16x32_bf16 v[32:35], a[88:91], a[40:43], v[32:35]
v_exp_f32 v50, v50
v_mfma_f32_16x16x32_bf16 v[32:35], a[92:95], a[44:47], v[32:35]
v_add_f32 v12, v12, v49
v_cvt_pk_bf16_f32 v64, v48, v49
v_exp_f32 v51, v51
v_add_f32 v12, v12, v50
s_add_u32 m0, s38, 0
s_add_u32 s54, s37, 65536
v_mfma_f32_16x16x32_bf16 v[36:39], a[96:99], a[32:35], v[24:27]
v_exp_f32 v52, v52
v_mfma_f32_16x16x32_bf16 v[36:39], a[100:103], a[36:39], v[36:39]
buffer_load_dwordx4 v68, s[24:27], s54 offen offset:0 sc1 nt lds
v_add_f32 v12, v12, v51
v_cvt_pk_bf16_f32 v65, v50, v51
v_exp_f32 v53, v53
v_add_f32 v12, v12, v52
v_mfma_f32_16x16x32_bf16 v[36:39], a[104:107], a[40:43], v[36:39]
v_exp_f32 v54, v54
v_mfma_f32_16x16x32_bf16 v[36:39], a[108:111], a[44:47], v[36:39]
v_add_f32 v12, v12, v53
v_cvt_pk_bf16_f32 v66, v52, v53
v_exp_f32 v55, v55
v_add_f32 v12, v12, v54
v_mfma_f32_16x16x32_bf16 v[40:43], a[176:179], a[32:35], v[24:27]
v_exp_f32 v32, v32
v_mfma_f32_16x16x32_bf16 v[40:43], a[180:183], a[36:39], v[40:43]
v_add_f32 v12, v12, v55
v_cvt_pk_bf16_f32 v67, v54, v55
v_mfma_f32_16x16x32_bf16 v[40:43], a[184:187], a[40:43], v[40:43]
v_exp_f32 v33, v33
v_mfma_f32_16x16x32_bf16 v[40:43], a[188:191], a[44:47], v[40:43]
buffer_load_dwordx4 v69, s[24:27], s54 offen offset:1088 sc1 nt lds
v_add_f32 v12, v12, v32
v_mfma_f32_16x16x32_bf16 v[44:47], a[192:195], a[32:35], v[24:27]
v_exp_f32 v34, v34
v_mfma_f32_16x16x32_bf16 v[44:47], a[196:199], a[36:39], v[44:47]
v_add_f32 v12, v12, v33
v_cvt_pk_bf16_f32 v56, v32, v33
v_mfma_f32_16x16x32_bf16 v[44:47], a[200:203], a[40:43], v[44:47]
v_exp_f32 v35, v35
v_mfma_f32_16x16x32_bf16 v[44:47], a[204:207], a[44:47], v[44:47]
buffer_load_dwordx4 v70, s[24:27], s54 offen offset:2176 sc1 nt lds
v_add_f32 v12, v12, v34
v_mfma_f32_16x16x32_bf16 v[192:195], a[112:115], v[64:67], 0
v_exp_f32 v36, v36
v_mfma_f32_16x16x32_bf16 v[196:199], a[116:119], v[64:67], 0
v_add_f32 v12, v12, v35
v_cvt_pk_bf16_f32 v57, v34, v35
v_mfma_f32_16x16x32_bf16 v[200:203], a[120:123], v[64:67], 0
v_exp_f32 v37, v37
v_mfma_f32_16x16x32_bf16 v[204:207], a[124:127], v[64:67], 0
buffer_load_dwordx4 v71, s[24:27], s54 offen offset:3264 sc1 nt lds
v_add_f32 v12, v12, v36
v_mfma_f32_16x16x32_bf16 v[208:211], a[128:131], v[64:67], 0
v_exp_f32 v38, v38
v_mfma_f32_16x16x32_bf16 v[212:215], a[132:135], v[64:67], 0
v_add_f32 v12, v12, v37
v_cvt_pk_bf16_f32 v58, v36, v37
v_mfma_f32_16x16x32_bf16 v[216:219], a[136:139], v[64:67], 0
v_exp_f32 v39, v39
v_mfma_f32_16x16x32_bf16 v[220:223], a[140:143], v[64:67], 0
v_add_f32 v12, v12, v38
v_add_u32 v7, 69632, v4
v_add_u32 v8, 69632, v5
v_add_u32 v9, 69632, v6
s_add_u32 m0, s38, 17408
s_add_u32 s54, s37, 65536
buffer_load_dwordx4 v72, s[28:31], s54 offen offset:0 sc1 nt lds
buffer_load_dwordx4 v73, s[28:31], s54 offen offset:1088 sc1 nt lds
buffer_load_dwordx4 v74, s[28:31], s54 offen offset:2176 sc1 nt lds
buffer_load_dwordx4 v75, s[28:31], s54 offen offset:3264 sc1 nt lds
s_waitcnt vmcnt(16) lgkmcnt(0)
s_barrier
L_join:
v_mfma_f32_16x16x32_bf16 v[48:51], a[208:211], a[32:35], v[24:27]
v_exp_f32 v40, v40
v_mfma_f32_16x16x32_bf16 v[48:51], a[212:215], a[36:39], v[48:51]
ds_read_b128 a[48:51], v7 offset:0
ds_read_b128 a[52:55], v7 offset:64
v_add_f32 v12, v12, v39
v_cvt_pk_bf16_f32 v59, v38, v39
s_add_u32 m0, s38, 34816
s_add_u32 s54, s37, 81920
v_mfma_f32_16x16x32_bf16 v[48:51], a[216:219], a[40:43], v[48:51]
v_exp_f32 v41, v41
v_mfma_f32_16x16x32_bf16 v[48:51], a[220:223], a[44:47], v[48:51]
ds_read_b128 a[56:59], v7 offset:128
v_add_f32 v12, v12, v40
v_mfma_f32_16x16x32_bf16 v[52:55], a[224:227], a[32:35], v[24:27]
v_exp_f32 v42, v42
v_mfma_f32_16x16x32_bf16 v[52:55], a[228:231], a[36:39], v[52:55]
buffer_load_dwordx4 v68, s[24:27], s54 offen offset:0 sc1 nt lds
ds_read_b128 a[60:63], v7 offset:192
v_add_f32 v12, v12, v41
v_cvt_pk_bf16_f32 v60, v40, v41
v_mfma_f32_16x16x32_bf16 v[52:55], a[232:235], a[40:43], v[52:55]
v_exp_f32 v43, v43
v_mfma_f32_16x16x32_bf16 v[52:55], a[236:239], a[44:47], v[52:55]
ds_read_b128 a[64:67], v7 offset:4352
ds_read_b128 a[68:71], v7 offset:4416
v_add_f32 v12, v12, v42
v_mfma_f32_16x16x32_bf16 v[192:195], a[144:147], v[56:59], v[192:195]
v_exp_f32 v44, v44
v_mfma_f32_16x16x32_bf16 v[196:199], a[148:151], v[56:59], v[196:199]
ds_read_b128 a[72:75], v7 offset:4480
v_add_f32 v12, v12, v43
v_cvt_pk_bf16_f32 v61, v42, v43
v_mfma_f32_16x16x32_bf16 v[200:203], a[152:155], v[56:59], v[200:203]
v_exp_f32 v45, v45
v_mfma_f32_16x16x32_bf16 v[204:207], a[156:159], v[56:59], v[204:207]
ds_read_b128 a[76:79], v7 offset:4544
v_add_f32 v12, v12, v44
v_mfma_f32_16x16x32_bf16 v[208:211], a[160:163], v[56:59], v[208:211]
v_exp_f32 v46, v46
v_mfma_f32_16x16x32_bf16 v[212:215], a[164:167], v[56:59], v[212:215]
buffer_load_dwordx4 v69, s[24:27], s54 offen offset:1088 sc1 nt lds
v_add_f32 v12, v12, v45
v_cvt_pk_bf16_f32 v62, v44, v45
v_mfma_f32_16x16x32_bf16 v[216:219], a[168:171], v[56:59], v[216:219]
v_exp_f32 v47, v47
v_mfma_f32_16x16x32_bf16 v[220:223], a[172:175], v[56:59], v[220:223]
v_add_f32 v12, v12, v46
s_waitcnt lgkmcnt(0)
v_mfma_f32_16x16x32_bf16 v[32:35], a[48:51], a[0:3], v[16:19]
v_exp_f32 v48, v48
v_mfma_f32_16x16x32_bf16 v[32:35], a[52:55], a[4:7], v[32:35]
ds_read_b64_tr_b16 a[112:113], v8 offset:17408
v_add_f32 v12, v12, v47
v_cvt_pk_bf16_f32 v63, v46, v47
v_mfma_f32_16x16x32_bf16 v[32:35], a[56:59], a[8:11], v[32:35]
v_exp_f32 v49, v49
v_mfma_f32_16x16x32_bf16 v[32:35], a[60:63], a[12:15], v[32:35]
ds_read_b64_tr_b16 a[114:115], v8 offset:21760
v_add_f32 v12, v12, v48
v_mfma_f32_16x16x32_bf16 v[36:39], a[64:67], a[0:3], v[16:19]
v_exp_f32 v50, v50
v_mfma_f32_16x16x32_bf16 v[36:39], a[68:71], a[4:7], v[36:39]
buffer_load_dwordx4 v70, s[24:27], s54 offen offset:2176 sc1 nt lds
ds_read_b64_tr_b16 a[116:117], v9 offset:17408
v_add_f32 v12, v12, v49
v_cvt_pk_bf16_f32 v64, v48, v49
v_mfma_f32_16x16x32_bf16 v[36:39], a[72:75], a[8:11], v[36:39]
v_exp_f32 v51, v51
v_mfma_f32_16x16x32_bf16 v[36:39], a[76:79], a[12:15], v[36:39]
ds_read_b64_tr_b16 a[118:119], v9 offset:21760
v_add_f32 v12, v12, v50
v_mfma_f32_16x16x32_bf16 v[192:195], v[224:227], v[60:63], v[192:195]
v_exp_f32 v52, v52
v_mfma_f32_16x16x32_bf16 v[196:199], v[228:231], v[60:63], v[196:199]
ds_read_b64_tr_b16 a[120:121], v8 offset:17472
v_add_f32 v12, v12, v51
v_cvt_pk_bf16_f32 v65, v50, v51
v_mfma_f32_16x16x32_bf16 v[200:203], v[232:235], v[60:63], v[200:203]
v_exp_f32 v53, v53
v_mfma_f32_16x16x32_bf16 v[204:207], v[236:239], v[60:63], v[204:207]
ds_read_b64_tr_b16 a[122:123], v8 offset:21824
v_add_f32 v12, v12, v52
v_mfma_f32_16x16x32_bf16 v[208:211], v[240:243], v[60:63], v[208:211]
v_exp_f32 v54, v54
v_mfma_f32_16x16x32_bf16 v[212:215], v[244:247], v[60:63], v[212:215]
buffer_load_dwordx4 v71, s[24:27], s54 offen offset:3264 sc1 nt lds
ds_read_b64_tr_b16 a[124:125], v9 offset:17472
v_add_f32 v12, v12, v53
v_cvt_pk_bf16_f32 v66, v52, v53
v_mfma_f32_16x16x32_bf16 v[216:219], v[248:251], v[60:63], v[216:219]
v_exp_f32 v55, v55
v_mfma_f32_16x16x32_bf16 v[220:223], v[252:255], v[60:63], v[220:223]
ds_read_b64_tr_b16 a[126:127], v9 offset:21824
v_add_f32 v12, v12, v54
v_mfma_f32_16x16x32_bf16 v[40:43], a[48:51], a[16:19], v[20:23]
v_exp_f32 v32, v32
v_mfma_f32_16x16x32_bf16 v[40:43], a[52:55], a[20:23], v[40:43]
ds_read_b64_tr_b16 a[128:129], v8 offset:17536
v_add_f32 v12, v12, v55
v_cvt_pk_bf16_f32 v67, v54, v55
v_mfma_f32_16x16x32_bf16 v[40:43], a[56:59], a[24:27], v[40:43]
v_exp_f32 v33, v33
v_mfma_f32_16x16x32_bf16 v[40:43], a[60:63], a[28:31], v[40:43]
ds_read_b64_tr_b16 a[130:131], v8 offset:21888
v_add_f32 v10, v10, v32
v_mfma_f32_16x16x32_bf16 v[44:47], a[64:67], a[16:19], v[20:23]
v_exp_f32 v34, v34
v_mfma_f32_16x16x32_bf16 v[44:47], a[68:71], a[20:23], v[44:47]
L_pg1:
s_cbranch_execz L_pg_done
ds_read_b64_tr_b16 a[132:133], v9 offset:17536
v_add_f32 v10, v10, v33
v_cvt_pk_bf16_f32 v56, v32, v33
v_mfma_f32_16x16x32_bf16 v[44:47], a[72:75], a[24:27], v[44:47]
v_exp_f32 v35, v35
v_mfma_f32_16x16x32_bf16 v[44:47], a[76:79], a[28:31], v[44:47]
ds_read_b64_tr_b16 a[134:135], v9 offset:21888
v_add_f32 v10, v10, v34
v_mfma_f32_16x16x32_bf16 v[192:195], v[96:99], v[64:67], v[192:195]
v_exp_f32 v36, v36
v_mfma_f32_16x16x32_bf16 v[196:199], v[100:103], v[64:67], v[196:199]
ds_read_b64_tr_b16 a[136:137], v8 offset:17600
v_add_f32 v10, v10, v35
v_cvt_pk_bf16_f32 v57, v34, v35
v_mfma_f32_16x16x32_bf16 v[200:203], v[104:107], v[64:67], v[200:203]
v_exp_f32 v37, v37
v_mfma_f32_16x16x32_bf16 v[204:207], v[108:111], v[64:67], v[204:207]
ds_read_b64_tr_b16 a[138:139], v8 offset:21952
v_add_f32 v10, v10, v36
v_mfma_f32_16x16x32_bf16 v[208:211], v[112:115], v[64:67], v[208:211]
v_exp_f32 v38, v38
v_mfma_f32_16x16x32_bf16 v[212:215], v[116:119], v[64:67], v[212:215]
ds_read_b64_tr_b16 a[140:141], v9 offset:17600
v_add_f32 v10, v10, v37
v_cvt_pk_bf16_f32 v58, v36, v37
v_mfma_f32_16x16x32_bf16 v[216:219], v[120:123], v[64:67], v[216:219]
v_exp_f32 v39, v39
v_mfma_f32_16x16x32_bf16 v[220:223], v[124:127], v[64:67], v[220:223]
ds_read_b64_tr_b16 a[142:143], v9 offset:21952
v_add_f32 v10, v10, v38
v_mfma_f32_16x16x32_bf16 v[48:51], a[48:51], a[32:35], v[24:27]
v_exp_f32 v40, v40
v_mfma_f32_16x16x32_bf16 v[48:51], a[52:55], a[36:39], v[48:51]
ds_read_b128 a[80:83], v7 offset:8704
ds_read_b128 a[84:87], v7 offset:8768
v_add_f32 v10, v10, v39
v_cvt_pk_bf16_f32 v59, v38, v39
s_add_u32 m0, s38, 52224
v_mfma_f32_16x16x32_bf16 v[48:51], a[56:59], a[40:43], v[48:51]
v_exp_f32 v41, v41
v_mfma_f32_16x16x32_bf16 v[48:51], a[60:63], a[44:47], v[48:51]
ds_read_b128 a[88:91], v7 offset:8832
v_add_f32 v11, v11, v40
v_mfma_f32_16x16x32_bf16 v[52:55], a[64:67], a[32:35], v[24:27]
v_exp_f32 v42, v42
v_mfma_f32_16x16x32_bf16 v[52:55], a[68:71], a[36:39], v[52:55]
buffer_load_dwordx4 v72, s[28:31], s54 offen offset:0 sc1 nt lds
ds_read_b128 a[92:95], v7 offset:8896
v_add_f32 v11, v11, v41
v_cvt_pk_bf16_f32 v60, v40, v41
v_mfma_f32_16x16x32_bf16 v[52:55], a[72:75], a[40:43], v[52:55]
v_exp_f32 v43, v43
v_mfma_f32_16x16x32_bf16 v[52:55], a[76:79], a[44:47], v[52:55]
ds_read_b128 a[96:99], v7 offset:13056
ds_read_b128 a[100:103], v7 offset:13120
v_add_f32 v11, v11, v42
s_waitcnt lgkmcnt(6)
v_mfma_f32_16x16x32_bf16 v[128:131], a[112:115], v[56:59], v[128:131]
v_exp_f32 v44, v44
v_mfma_f32_16x16x32_bf16 v[132:135], a[116:119], v[56:59], v[132:135]
ds_read_b128 a[104:107], v7 offset:13184
v_add_f32 v11, v11, v43
v_cvt_pk_bf16_f32 v61, v42, v43
v_mfma_f32_16x16x32_bf16 v[136:139], a[120:123], v[56:59], v[136:139]
v_exp_f32 v45, v45
v_mfma_f32_16x16x32_bf16 v[140:143], a[124:127], v[56:59], v[140:143]
ds_read_b128 a[108:111], v7 offset:13248
v_add_f32 v11, v11, v44
v_mfma_f32_16x16x32_bf16 v[144:147], a[128:131], v[56:59], v[144:147]
v_exp_f32 v46, v46
v_mfma_f32_16x16x32_bf16 v[148:151], a[132:135], v[56:59], v[148:151]
buffer_load_dwordx4 v73, s[28:31], s54 offen offset:1088 sc1 nt lds
v_add_f32 v11, v11, v45
v_cvt_pk_bf16_f32 v62, v44, v45
v_mfma_f32_16x16x32_bf16 v[152:155], a[136:139], v[56:59], v[152:155]
v_exp_f32 v47, v47
v_mfma_f32_16x16x32_bf16 v[156:159], a[140:143], v[56:59], v[156:159]
v_add_f32 v11, v11, v46
s_waitcnt lgkmcnt(0)
v_mfma_f32_16x16x32_bf16 v[32:35], a[80:83], a[0:3], v[16:19]
v_exp_f32 v48, v48
v_mfma_f32_16x16x32_bf16 v[32:35], a[84:87], a[4:7], v[32:35]
ds_read_b64_tr_b16 a[144:145], v8 offset:26112
v_add_f32 v11, v11, v47
v_cvt_pk_bf16_f32 v63, v46, v47
v_mfma_f32_16x16x32_bf16 v[32:35], a[88:91], a[8:11], v[32:35]
v_exp_f32 v49, v49
v_mfma_f32_16x16x32_bf16 v[32:35], a[92:95], a[12:15], v[32:35]
ds_read_b64_tr_b16 a[146:147], v8 offset:30464
v_add_f32 v12, v12, v48
v_mfma_f32_16x16x32_bf16 v[36:39], a[96:99], a[0:3], v[16:19]
v_exp_f32 v50, v50
v_mfma_f32_16x16x32_bf16 v[36:39], a[100:103], a[4:7], v[36:39]
buffer_load_dwordx4 v74, s[28:31], s54 offen offset:2176 sc1 nt lds
ds_read_b64_tr_b16 a[148:149], v9 offset:26112
v_add_f32 v12, v12, v49
v_cvt_pk_bf16_f32 v64, v48, v49
v_mfma_f32_16x16x32_bf16 v[36:39], a[104:107], a[8:11], v[36:39]
v_exp_f32 v51, v51
v_mfma_f32_16x16x32_bf16 v[36:39], a[108:111], a[12:15], v[36:39]
ds_read_b64_tr_b16 a[150:151], v9 offset:30464
v_add_f32 v12, v12, v50
v_mfma_f32_16x16x32_bf16 v[160:163], a[112:115], v[60:63], v[160:163]
v_exp_f32 v52, v52
v_mfma_f32_16x16x32_bf16 v[164:167], a[116:119], v[60:63], v[164:167]
ds_read_b64_tr_b16 a[152:153], v8 offset:26176
v_add_f32 v12, v12, v51
v_cvt_pk_bf16_f32 v65, v50, v51
v_mfma_f32_16x16x32_bf16 v[168:171], a[120:123], v[60:63], v[168:171]
v_exp_f32 v53, v53
v_mfma_f32_16x16x32_bf16 v[172:175], a[124:127], v[60:63], v[172:175]
ds_read_b64_tr_b16 a[154:155], v8 offset:30528
v_add_f32 v12, v12, v52
v_mfma_f32_16x16x32_bf16 v[176:179], a[128:131], v[60:63], v[176:179]
v_exp_f32 v54, v54
v_mfma_f32_16x16x32_bf16 v[180:183], a[132:135], v[60:63], v[180:183]
buffer_load_dwordx4 v75, s[28:31], s54 offen offset:3264 sc1 nt lds
ds_read_b64_tr_b16 a[156:157], v9 offset:26176
v_add_f32 v12, v12, v53
v_cvt_pk_bf16_f32 v66, v52, v53
v_mfma_f32_16x16x32_bf16 v[184:187], a[136:139], v[60:63], v[184:187]
v_exp_f32 v55, v55
v_mfma_f32_16x16x32_bf16 v[188:191], a[140:143], v[60:63], v[188:191]
ds_read_b64_tr_b16 a[158:159], v9 offset:30528
v_add_f32 v12, v12, v54
v_mfma_f32_16x16x32_bf16 v[40:43], a[80:83], a[16:19], v[20:23]
v_exp_f32 v32, v32
v_mfma_f32_16x16x32_bf16 v[40:43], a[84:87], a[20:23], v[40:43]
ds_read_b64_tr_b16 a[160:161], v8 offset:26240
ds_read_b64_tr_b16 a[162:163], v8 offset:30592
v_add_f32 v12, v12, v55
v_cvt_pk_bf16_f32 v67, v54, v55
v_mfma_f32_16x16x32_bf16 v[40:43], a[88:91], a[24:27], v[40:43]
v_exp_f32 v33, v33
v_mfma_f32_16x16x32_bf16 v[40:43], a[92:95], a[28:31], v[40:43]
ds_read_b64_tr_b16 a[164:165], v9 offset:26240
v_add_f32 v10, v10, v32
v_mfma_f32_16x16x32_bf16 v[44:47], a[96:99], a[16:19], v[20:23]
v_exp_f32 v34, v34
v_mfma_f32_16x16x32_bf16 v[44:47], a[100:103], a[20:23], v[44:47]
ds_read_b64_tr_b16 a[166:167], v9 offset:30592
v_add_f32 v10, v10, v33
v_cvt_pk_bf16_f32 v56, v32, v33
v_mfma_f32_16x16x32_bf16 v[44:47], a[104:107], a[24:27], v[44:47]
v_exp_f32 v35, v35
v_mfma_f32_16x16x32_bf16 v[44:47], a[108:111], a[28:31], v[44:47]
ds_read_b64_tr_b16 a[168:169], v8 offset:26304
ds_read_b64_tr_b16 a[170:171], v8 offset:30656
v_add_f32 v10, v10, v34
v_mfma_f32_16x16x32_bf16 v[192:195], a[112:115], v[64:67], v[192:195]
v_exp_f32 v36, v36
v_mfma_f32_16x16x32_bf16 v[196:199], a[116:119], v[64:67], v[196:199]
ds_read_b64_tr_b16 a[172:173], v9 offset:26304
v_add_f32 v10, v10, v35
v_cvt_pk_bf16_f32 v57, v34, v35
v_mfma_f32_16x16x32_bf16 v[200:203], a[120:123], v[64:67], v[200:203]
v_exp_f32 v37, v37
v_mfma_f32_16x16x32_bf16 v[204:207], a[124:127], v[64:67], v[204:207]
ds_read_b64_tr_b16 a[174:175], v9 offset:30656
v_add_f32 v10, v10, v36
v_mfma_f32_16x16x32_bf16 v[208:211], a[128:131], v[64:67], v[208:211]
v_exp_f32 v38, v38
v_mfma_f32_16x16x32_bf16 v[212:215], a[132:135], v[64:67], v[212:215]
v_add_f32 v10, v10, v37
v_cvt_pk_bf16_f32 v58, v36, v37
v_add_u32 v7, 104448, v4
v_add_u32 v8, 104448, v5
v_add_u32 v9, 104448, v6
v_mfma_f32_16x16x32_bf16 v[216:219], a[136:139], v[64:67], v[216:219]
v_exp_f32 v39, v39
v_mfma_f32_16x16x32_bf16 v[220:223], a[140:143], v[64:67], v[220:223]
s_waitcnt vmcnt(16) lgkmcnt(0)
s_barrier
v_add_f32 v10, v10, v38
v_mfma_f32_16x16x32_bf16 v[48:51], a[80:83], a[32:35], v[24:27]
v_exp_f32 v40, v40
v_mfma_f32_16x16x32_bf16 v[48:51], a[84:87], a[36:39], v[48:51]
ds_read_b128 a[48:51], v7 offset:0
ds_read_b128 a[52:55], v7 offset:64
v_add_f32 v10, v10, v39
v_cvt_pk_bf16_f32 v59, v38, v39
v_mfma_f32_16x16x32_bf16 v[48:51], a[88:91], a[40:43], v[48:51]
v_exp_f32 v41, v41
v_mfma_f32_16x16x32_bf16 v[48:51], a[92:95], a[44:47], v[48:51]
ds_read_b128 a[56:59], v7 offset:128
v_add_f32 v11, v11, v40
s_add_u32 m0, s38, 69632
s_add_u32 s54, s37, 98304
v_mfma_f32_16x16x32_bf16 v[52:55], a[96:99], a[32:35], v[24:27]
v_exp_f32 v42, v42
v_mfma_f32_16x16x32_bf16 v[52:55], a[100:103], a[36:39], v[52:55]
ds_read_b128 a[60:63], v7 offset:192
v_add_f32 v11, v11, v41
v_cvt_pk_bf16_f32 v60, v40, v41
v_mfma_f32_16x16x32_bf16 v[52:55], a[104:107], a[40:43], v[52:55]
v_exp_f32 v43, v43
v_mfma_f32_16x16x32_bf16 v[52:55], a[108:111], a[44:47], v[52:55]
buffer_load_dwordx4 v68, s[24:27], s54 offen offset:0 sc1 nt lds
ds_read_b128 a[64:67], v7 offset:4352
ds_read_b128 a[68:71], v7 offset:4416
v_add_f32 v11, v11, v42
v_mfma_f32_16x16x32_bf16 v[128:131], a[144:147], v[56:59], v[128:131]
v_exp_f32 v44, v44
v_mfma_f32_16x16x32_bf16 v[132:135], a[148:151], v[56:59], v[132:135]
ds_read_b128 a[72:75], v7 offset:4480
v_add_f32 v11, v11, v43
v_cvt_pk_bf16_f32 v61, v42, v43
v_mfma_f32_16x16x32_bf16 v[136:139], a[152:155], v[56:59], v[136:139]
v_exp_f32 v45, v45
v_mfma_f32_16x16x32_bf16 v[140:143], a[156:159], v[56:59], v[140:143]
ds_read_b128 a[76:79], v7 offset:4544
v_add_f32 v11, v11, v44
v_mfma_f32_16x16x32_bf16 v[144:147], a[160:163], v[56:59], v[144:147]
v_exp_f32 v46, v46
v_mfma_f32_16x16x32_bf16 v[148:151], a[164:167], v[56:59], v[148:151]
v_add_f32 v11, v11, v45
v_cvt_pk_bf16_f32 v62, v44, v45
v_mfma_f32_16x16x32_bf16 v[152:155], a[168:171], v[56:59], v[152:155]
v_exp_f32 v47, v47
v_mfma_f32_16x16x32_bf16 v[156:159], a[172:175], v[56:59], v[156:159]
buffer_load_dwordx4 v69, s[24:27], s54 offen offset:1088 sc1 nt lds
v_add_f32 v11, v11, v46
s_waitcnt lgkmcnt(0)
v_mfma_f32_16x16x32_bf16 v[32:35], a[48:51], a[0:3], v[16:19]
v_exp_f32 v48, v48
v_mfma_f32_16x16x32_bf16 v[32:35], a[52:55], a[4:7], v[32:35]
ds_read_b64_tr_b16 a[112:113], v8 offset:17408
v_add_f32 v11, v11, v47
v_cvt_pk_bf16_f32 v63, v46, v47
v_mfma_f32_16x16x32_bf16 v[32:35], a[56:59], a[8:11], v[32:35]
v_exp_f32 v49, v49
v_mfma_f32_16x16x32_bf16 v[32:35], a[60:63], a[12:15], v[32:35]
ds_read_b64_tr_b16 a[114:115], v8 offset:21760
v_add_f32 v12, v12, v48
v_mfma_f32_16x16x32_bf16 v[36:39], a[64:67], a[0:3], v[16:19]
v_exp_f32 v50, v50
v_mfma_f32_16x16x32_bf16 v[36:39], a[68:71], a[4:7], v[36:39]
ds_read_b64_tr_b16 a[116:117], v9 offset:17408
v_add_f32 v12, v12, v49
v_cvt_pk_bf16_f32 v64, v48, v49
v_mfma_f32_16x16x32_bf16 v[36:39], a[72:75], a[8:11], v[36:39]
v_exp_f32 v51, v51
v_mfma_f32_16x16x32_bf16 v[36:39], a[76:79], a[12:15], v[36:39]
ds_read_b64_tr_b16 a[118:119], v9 offset:21760
v_add_f32 v12, v12, v50
v_mfma_f32_16x16x32_bf16 v[160:163], a[144:147], v[60:63], v[160:163]
v_exp_f32 v52, v52
v_mfma_f32_16x16x32_bf16 v[164:167], a[148:151], v[60:63], v[164:167]
ds_read_b64_tr_b16 a[120:121], v8 offset:17472
v_add_f32 v12, v12, v51
v_cvt_pk_bf16_f32 v65, v50, v51
v_mfma_f32_16x16x32_bf16 v[168:171], a[152:155], v[60:63], v[168:171]
v_exp_f32 v53, v53
v_mfma_f32_16x16x32_bf16 v[172:175], a[156:159], v[60:63], v[172:175]
buffer_load_dwordx4 v70, s[24:27], s54 offen offset:2176 sc1 nt lds
ds_read_b64_tr_b16 a[122:123], v8 offset:21824
v_add_f32 v12, v12, v52
v_mfma_f32_16x16x32_bf16 v[176:179], a[160:163], v[60:63], v[176:179]
v_exp_f32 v54, v54
v_mfma_f32_16x16x32_bf16 v[180:183], a[164:167], v[60:63], v[180:183]
ds_read_b64_tr_b16 a[124:125], v9 offset:17472
v_add_f32 v12, v12, v53
v_cvt_pk_bf16_f32 v66, v52, v53
v_mfma_f32_16x16x32_bf16 v[184:187], a[168:171], v[60:63], v[184:187]
v_exp_f32 v55, v55
v_mfma_f32_16x16x32_bf16 v[188:191], a[172:175], v[60:63], v[188:191]
ds_read_b64_tr_b16 a[126:127], v9 offset:21824
v_add_f32 v12, v12, v54
v_mfma_f32_16x16x32_bf16 v[40:43], a[48:51], a[16:19], v[20:23]
v_exp_f32 v32, v32
v_mfma_f32_16x16x32_bf16 v[40:43], a[52:55], a[20:23], v[40:43]
ds_read_b64_tr_b16 a[128:129], v8 offset:17536
v_add_f32 v12, v12, v55
v_cvt_pk_bf16_f32 v67, v54, v55
v_mfma_f32_16x16x32_bf16 v[40:43], a[56:59], a[24:27], v[40:43]
v_exp_f32 v33, v33
v_mfma_f32_16x16x32_bf16 v[40:43], a[60:63], a[28:31], v[40:43]
ds_read_b64_tr_b16 a[130:131], v8 offset:21888
v_add_f32 v10, v10, v32
v_mfma_f32_16x16x32_bf16 v[44:47], a[64:67], a[16:19], v[20:23]
v_exp_f32 v34, v34
v_mfma_f32_16x16x32_bf16 v[44:47], a[68:71], a[20:23], v[44:47]
ds_read_b64_tr_b16 a[132:133], v9 offset:17536
v_add_f32 v10, v10, v33
v_cvt_pk_bf16_f32 v56, v32, v33
v_mfma_f32_16x16x32_bf16 v[44:47], a[72:75], a[24:27], v[44:47]
v_exp_f32 v35, v35
v_mfma_f32_16x16x32_bf16 v[44:47], a[76:79], a[28:31], v[44:47]
buffer_load_dwordx4 v71, s[24:27], s54 offen offset:3264 sc1 nt lds
ds_read_b64_tr_b16 a[134:135], v9 offset:21888
v_add_f32 v10, v10, v34
v_mfma_f32_16x16x32_bf16 v[192:195], a[144:147], v[64:67], v[192:195]
v_exp_f32 v36, v36
v_mfma_f32_16x16x32_bf16 v[196:199], a[148:151], v[64:67], v[196:199]
ds_read_b64_tr_b16 a[136:137], v8 offset:17600
v_add_f32 v10, v10, v35
v_cvt_pk_bf16_f32 v57, v34, v35
v_mfma_f32_16x16x32_bf16 v[200:203], a[152:155], v[64:67], v[200:203]
v_exp_f32 v37, v37
v_mfma_f32_16x16x32_bf16 v[204:207], a[156:159], v[64:67], v[204:207]
ds_read_b64_tr_b16 a[138:139], v8 offset:21952
v_add_f32 v10, v10, v36
v_mfma_f32_16x16x32_bf16 v[208:211], a[160:163], v[64:67], v[208:211]
v_exp_f32 v38, v38
v_mfma_f32_16x16x32_bf16 v[212:215], a[164:167], v[64:67], v[212:215]
ds_read_b64_tr_b16 a[140:141], v9 offset:17600
v_add_f32 v10, v10, v37
v_cvt_pk_bf16_f32 v58, v36, v37
v_mfma_f32_16x16x32_bf16 v[216:219], a[168:171], v[64:67], v[216:219]
v_exp_f32 v39, v39
v_mfma_f32_16x16x32_bf16 v[220:223], a[172:175], v[64:67], v[220:223]
ds_read_b64_tr_b16 a[142:143], v9 offset:21952
v_add_f32 v10, v10, v38
v_mfma_f32_16x16x32_bf16 v[48:51], a[48:51], a[32:35], v[24:27]
v_exp_f32 v40, v40
v_mfma_f32_16x16x32_bf16 v[48:51], a[52:55], a[36:39], v[48:51]
ds_read_b128 a[80:83], v7 offset:8704
ds_read_b128 a[84:87], v7 offset:8768
v_add_f32 v10, v10, v39
v_cvt_pk_bf16_f32 v59, v38, v39
v_mfma_f32_16x16x32_bf16 v[48:51], a[56:59], a[40:43], v[48:51]
v_exp_f32 v41, v41
v_mfma_f32_16x16x32_bf16 v[48:51], a[60:63], a[44:47], v[48:51]
ds_read_b128 a[88:91], v7 offset:8832
v_add_f32 v11, v11, v40
s_add_u32 m0, s38, 87040
v_mfma_f32_16x16x32_bf16 v[52:55], a[64:67], a[32:35], v[24:27]
v_exp_f32 v42, v42
v_mfma_f32_16x16x32_bf16 v[52:55], a[68:71], a[36:39], v[52:55]
ds_read_b128 a[92:95], v7 offset:8896
v_add_f32 v11, v11, v41
v_cvt_pk_bf16_f32 v60, v40, v41
v_mfma_f32_16x16x32_bf16 v[52:55], a[72:75], a[40:43], v[52:55]
v_exp_f32 v43, v43
v_mfma_f32_16x16x32_bf16 v[52:55], a[76:79], a[44:47], v[52:55]
buffer_load_dwordx4 v72, s[28:31], s54 offen offset:0 sc1 nt lds
ds_read_b128 a[96:99], v7 offset:13056
ds_read_b128 a[100:103], v7 offset:13120
v_add_f32 v11, v11, v42
s_waitcnt lgkmcnt(6)
v_mfma_f32_16x16x32_bf16 v[128:131], a[112:115], v[56:59], v[128:131]
v_exp_f32 v44, v44
v_mfma_f32_16x16x32_bf16 v[132:135], a[116:119], v[56:59], v[132:135]
ds_read_b128 a[104:107], v7 offset:13184
v_add_f32 v11, v11, v43
v_cvt_pk_bf16_f32 v61, v42, v43
v_mfma_f32_16x16x32_bf16 v[136:139], a[120:123], v[56:59], v[136:139]
v_exp_f32 v45, v45
v_mfma_f32_16x16x32_bf16 v[140:143], a[124:127], v[56:59], v[140:143]
ds_read_b128 a[108:111], v7 offset:13248
v_add_f32 v11, v11, v44
v_mfma_f32_16x16x32_bf16 v[144:147], a[128:131], v[56:59], v[144:147]
v_exp_f32 v46, v46
v_mfma_f32_16x16x32_bf16 v[148:151], a[132:135], v[56:59], v[148:151]
v_add_f32 v11, v11, v45
v_cvt_pk_bf16_f32 v62, v44, v45
v_mfma_f32_16x16x32_bf16 v[152:155], a[136:139], v[56:59], v[152:155]
v_exp_f32 v47, v47
v_mfma_f32_16x16x32_bf16 v[156:159], a[140:143], v[56:59], v[156:159]
buffer_load_dwordx4 v73, s[28:31], s54 offen offset:1088 sc1 nt lds
v_add_f32 v11, v11, v46
s_waitcnt lgkmcnt(0)
v_mfma_f32_16x16x32_bf16 v[32:35], a[80:83], a[0:3], v[16:19]
v_exp_f32 v48, v48
v_mfma_f32_16x16x32_bf16 v[32:35], a[84:87], a[4:7], v[32:35]
ds_read_b64_tr_b16 a[144:145], v8 offset:26112
v_add_f32 v11, v11, v47
v_cvt_pk_bf16_f32 v63, v46, v47
v_mfma_f32_16x16x32_bf16 v[32:35], a[88:91], a[8:11], v[32:35]
v_exp_f32 v49, v49
v_mfma_f32_16x16x32_bf16 v[32:35], a[92:95], a[12:15], v[32:35]
ds_read_b64_tr_b16 a[146:147], v8 offset:30464
v_add_f32 v12, v12, v48
v_mfma_f32_16x16x32_bf16 v[36:39], a[96:99], a[0:3], v[16:19]
v_exp_f32 v50, v50
v_mfma_f32_16x16x32_bf16 v[36:39], a[100:103], a[4:7], v[36:39]
ds_read_b64_tr_b16 a[148:149], v9 offset:26112
v_add_f32 v12, v12, v49
v_cvt_pk_bf16_f32 v64, v48, v49
v_mfma_f32_16x16x32_bf16 v[36:39], a[104:107], a[8:11], v[36:39]
v_exp_f32 v51, v51
v_mfma_f32_16x16x32_bf16 v[36:39], a[108:111], a[12:15], v[36:39]
ds_read_b64_tr_b16 a[150:151], v9 offset:30464
v_add_f32 v12, v12, v50
v_mfma_f32_16x16x32_bf16 v[160:163], a[112:115], v[60:63], v[160:163]
v_exp_f32 v52, v52
v_mfma_f32_16x16x32_bf16 v[164:167], a[116:119], v[60:63], v[164:167]
ds_read_b64_tr_b16 a[152:153], v8 offset:26176
v_add_f32 v12, v12, v51
v_cvt_pk_bf16_f32 v65, v50, v51
v_mfma_f32_16x16x32_bf16 v[168:171], a[120:123], v[60:63], v[168:171]
v_exp_f32 v53, v53
v_mfma_f32_16x16x32_bf16 v[172:175], a[124:127], v[60:63], v[172:175]
buffer_load_dwordx4 v74, s[28:31], s54 offen offset:2176 sc1 nt lds
ds_read_b64_tr_b16 a[154:155], v8 offset:30528
v_add_f32 v12, v12, v52
v_mfma_f32_16x16x32_bf16 v[176:179], a[128:131], v[60:63], v[176:179]
v_exp_f32 v54, v54
v_mfma_f32_16x16x32_bf16 v[180:183], a[132:135], v[60:63], v[180:183]
ds_read_b64_tr_b16 a[156:157], v9 offset:26176
v_add_f32 v12, v12, v53
v_cvt_pk_bf16_f32 v66, v52, v53
v_mfma_f32_16x16x32_bf16 v[184:187], a[136:139], v[60:63], v[184:187]
v_exp_f32 v55, v55
v_mfma_f32_16x16x32_bf16 v[188:191], a[140:143], v[60:63], v[188:191]
ds_read_b64_tr_b16 a[158:159], v9 offset:30528
v_add_f32 v12, v12, v54
v_mfma_f32_16x16x32_bf16 v[40:43], a[80:83], a[16:19], v[20:23]
v_exp_f32 v32, v32
v_mfma_f32_16x16x32_bf16 v[40:43], a[84:87], a[20:23], v[40:43]
ds_read_b64_tr_b16 a[160:161], v8 offset:26240
ds_read_b64_tr_b16 a[162:163], v8 offset:30592
v_add_f32 v12, v12, v55
v_cvt_pk_bf16_f32 v67, v54, v55
v_mfma_f32_16x16x32_bf16 v[40:43], a[88:91], a[24:27], v[40:43]
v_exp_f32 v33, v33
v_mfma_f32_16x16x32_bf16 v[40:43], a[92:95], a[28:31], v[40:43]
ds_read_b64_tr_b16 a[164:165], v9 offset:26240
v_add_f32 v10, v10, v32
v_mfma_f32_16x16x32_bf16 v[44:47], a[96:99], a[16:19], v[20:23]
v_exp_f32 v34, v34
v_mfma_f32_16x16x32_bf16 v[44:47], a[100:103], a[20:23], v[44:47]
ds_read_b64_tr_b16 a[166:167], v9 offset:30592
v_add_f32 v10, v10, v33
v_cvt_pk_bf16_f32 v56, v32, v33
v_mfma_f32_16x16x32_bf16 v[44:47], a[104:107], a[24:27], v[44:47]
v_exp_f32 v35, v35
v_mfma_f32_16x16x32_bf16 v[44:47], a[108:111], a[28:31], v[44:47]
buffer_load_dwordx4 v75, s[28:31], s54 offen offset:3264 sc1 nt lds
ds_read_b64_tr_b16 a[168:169], v8 offset:26304
ds_read_b64_tr_b16 a[170:171], v8 offset:30656
v_add_f32 v10, v10, v34
v_mfma_f32_16x16x32_bf16 v[192:195], a[112:115], v[64:67], v[192:195]
v_exp_f32 v36, v36
v_mfma_f32_16x16x32_bf16 v[196:199], a[116:119], v[64:67], v[196:199]
ds_read_b64_tr_b16 a[172:173], v9 offset:26304
v_add_f32 v10, v10, v35
v_cvt_pk_bf16_f32 v57, v34, v35
v_mfma_f32_16x16x32_bf16 v[200:203], a[120:123], v[64:67], v[200:203]
v_exp_f32 v37, v37
v_mfma_f32_16x16x32_bf16 v[204:207], a[124:127], v[64:67], v[204:207]
ds_read_b64_tr_b16 a[174:175], v9 offset:30656
v_add_f32 v10, v10, v36
v_mfma_f32_16x16x32_bf16 v[208:211], a[128:131], v[64:67], v[208:211]
v_exp_f32 v38, v38
v_mfma_f32_16x16x32_bf16 v[212:215], a[132:135], v[64:67], v[212:215]
v_add_f32 v10, v10, v37
v_cvt_pk_bf16_f32 v58, v36, v37
v_mov_b32 v7, v4
v_mov_b32 v8, v5
v_mov_b32 v9, v6
v_mfma_f32_16x16x32_bf16 v[216:219], a[136:139], v[64:67], v[216:219]
v_exp_f32 v39, v39
v_mfma_f32_16x16x32_bf16 v[220:223], a[140:143], v[64:67], v[220:223]
s_waitcnt vmcnt(16) lgkmcnt(0)
s_barrier
v_add_f32 v10, v10, v38
v_mfma_f32_16x16x32_bf16 v[48:51], a[80:83], a[32:35], v[24:27]
v_exp_f32 v40, v40
v_mfma_f32_16x16x32_bf16 v[48:51], a[84:87], a[36:39], v[48:51]
ds_read_b128 a[48:51], v7 offset:0
ds_read_b128 a[52:55], v7 offset:64
v_add_f32 v10, v10, v39
v_cvt_pk_bf16_f32 v59, v38, v39
v_mfma_f32_16x16x32_bf16 v[48:51], a[88:91], a[40:43], v[48:51]
v_exp_f32 v41, v41
v_mfma_f32_16x16x32_bf16 v[48:51], a[92:95], a[44:47], v[48:51]
ds_read_b128 a[56:59], v7 offset:128
v_add_f32 v11, v11, v40
s_add_u32 m0, s38, 104448
s_add_u32 s54, s37, 114688
v_mfma_f32_16x16x32_bf16 v[52:55], a[96:99], a[32:35], v[24:27]
v_exp_f32 v42, v42
v_mfma_f32_16x16x32_bf16 v[52:55], a[100:103], a[36:39], v[52:55]
ds_read_b128 a[60:63], v7 offset:192
v_add_f32 v11, v11, v41
v_cvt_pk_bf16_f32 v60, v40, v41
v_mfma_f32_16x16x32_bf16 v[52:55], a[104:107], a[40:43], v[52:55]
v_exp_f32 v43, v43
v_mfma_f32_16x16x32_bf16 v[52:55], a[108:111], a[44:47], v[52:55]
buffer_load_dwordx4 v68, s[24:27], s54 offen offset:0 sc1 nt lds
ds_read_b128 a[64:67], v7 offset:4352
ds_read_b128 a[68:71], v7 offset:4416
v_add_f32 v11, v11, v42
v_mfma_f32_16x16x32_bf16 v[128:131], a[144:147], v[56:59], v[128:131]
v_exp_f32 v44, v44
v_mfma_f32_16x16x32_bf16 v[132:135], a[148:151], v[56:59], v[132:135]
ds_read_b128 a[72:75], v7 offset:4480
v_add_f32 v11, v11, v43
v_cvt_pk_bf16_f32 v61, v42, v43
v_mfma_f32_16x16x32_bf16 v[136:139], a[152:155], v[56:59], v[136:139]
v_exp_f32 v45, v45
v_mfma_f32_16x16x32_bf16 v[140:143], a[156:159], v[56:59], v[140:143]
ds_read_b128 a[76:79], v7 offset:4544
v_add_f32 v11, v11, v44
v_mfma_f32_16x16x32_bf16 v[144:147], a[160:163], v[56:59], v[144:147]
v_exp_f32 v46, v46
v_mfma_f32_16x16x32_bf16 v[148:151], a[164:167], v[56:59], v[148:151]
v_add_f32 v11, v11, v45
v_cvt_pk_bf16_f32 v62, v44, v45
v_mfma_f32_16x16x32_bf16 v[152:155], a[168:171], v[56:59], v[152:155]
v_exp_f32 v47, v47
v_mfma_f32_16x16x32_bf16 v[156:159], a[172:175], v[56:59], v[156:159]
buffer_load_dwordx4 v69, s[24:27], s54 offen offset:1088 sc1 nt lds
v_add_f32 v11, v11, v46
s_waitcnt lgkmcnt(0)
v_mfma_f32_16x16x32_bf16 v[32:35], a[48:51], a[0:3], v[16:19]
v_exp_f32 v48, v48
v_mfma_f32_16x16x32_bf16 v[32:35], a[52:55], a[4:7], v[32:35]
ds_read_b64_tr_b16 a[112:113], v8 offset:17408
v_add_f32 v11, v11, v47
v_cvt_pk_bf16_f32 v63, v46, v47
v_mfma_f32_16x16x32_bf16 v[32:35], a[56:59], a[8:11], v[32:35]
v_exp_f32 v49, v49
v_mfma_f32_16x16x32_bf16 v[32:35], a[60:63], a[12:15], v[32:35]
ds_read_b64_tr_b16 a[114:115], v8 offset:21760
v_add_f32 v12, v12, v48
v_mfma_f32_16x16x32_bf16 v[36:39], a[64:67], a[0:3], v[16:19]
v_exp_f32 v50, v50
v_mfma_f32_16x16x32_bf16 v[36:39], a[68:71], a[4:7], v[36:39]
ds_read_b64_tr_b16 a[116:117], v9 offset:17408
v_add_f32 v12, v12, v49
v_cvt_pk_bf16_f32 v64, v48, v49
v_mfma_f32_16x16x32_bf16 v[36:39], a[72:75], a[8:11], v[36:39]
v_exp_f32 v51, v51
v_mfma_f32_16x16x32_bf16 v[36:39], a[76:79], a[12:15], v[36:39]
ds_read_b64_tr_b16 a[118:119], v9 offset:21760
v_add_f32 v12, v12, v50
v_mfma_f32_16x16x32_bf16 v[160:163], a[144:147], v[60:63], v[160:163]
v_exp_f32 v52, v52
v_mfma_f32_16x16x32_bf16 v[164:167], a[148:151], v[60:63], v[164:167]
ds_read_b64_tr_b16 a[120:121], v8 offset:17472
v_add_f32 v12, v12, v51
v_cvt_pk_bf16_f32 v65, v50, v51
v_mfma_f32_16x16x32_bf16 v[168:171], a[152:155], v[60:63], v[168:171]
v_exp_f32 v53, v53
v_mfma_f32_16x16x32_bf16 v[172:175], a[156:159], v[60:63], v[172:175]
buffer_load_dwordx4 v70, s[24:27], s54 offen offset:2176 sc1 nt lds
ds_read_b64_tr_b16 a[122:123], v8 offset:21824
v_add_f32 v12, v12, v52
v_mfma_f32_16x16x32_bf16 v[176:179], a[160:163], v[60:63], v[176:179]
v_exp_f32 v54, v54
v_mfma_f32_16x16x32_bf16 v[180:183], a[164:167], v[60:63], v[180:183]
ds_read_b64_tr_b16 a[124:125], v9 offset:17472
v_add_f32 v12, v12, v53
v_cvt_pk_bf16_f32 v66, v52, v53
v_mfma_f32_16x16x32_bf16 v[184:187], a[168:171], v[60:63], v[184:187]
v_exp_f32 v55, v55
v_mfma_f32_16x16x32_bf16 v[188:191], a[172:175], v[60:63], v[188:191]
ds_read_b64_tr_b16 a[126:127], v9 offset:21824
v_add_f32 v12, v12, v54
v_mfma_f32_16x16x32_bf16 v[40:43], a[48:51], a[16:19], v[20:23]
v_exp_f32 v32, v32
v_mfma_f32_16x16x32_bf16 v[40:43], a[52:55], a[20:23], v[40:43]
ds_read_b64_tr_b16 a[128:129], v8 offset:17536
v_add_f32 v12, v12, v55
v_cvt_pk_bf16_f32 v67, v54, v55
v_mfma_f32_16x16x32_bf16 v[40:43], a[56:59], a[24:27], v[40:43]
v_exp_f32 v33, v33
v_mfma_f32_16x16x32_bf16 v[40:43], a[60:63], a[28:31], v[40:43]
ds_read_b64_tr_b16 a[130:131], v8 offset:21888
v_add_f32 v10, v10, v32
v_mfma_f32_16x16x32_bf16 v[44:47], a[64:67], a[16:19], v[20:23]
v_exp_f32 v34, v34
v_mfma_f32_16x16x32_bf16 v[44:47], a[68:71], a[20:23], v[44:47]
ds_read_b64_tr_b16 a[132:133], v9 offset:17536
v_add_f32 v10, v10, v33
v_cvt_pk_bf16_f32 v56, v32, v33
v_mfma_f32_16x16x32_bf16 v[44:47], a[72:75], a[24:27], v[44:47]
v_exp_f32 v35, v35
v_mfma_f32_16x16x32_bf16 v[44:47], a[76:79], a[28:31], v[44:47]
buffer_load_dwordx4 v71, s[24:27], s54 offen offset:3264 sc1 nt lds
ds_read_b64_tr_b16 a[134:135], v9 offset:21888
v_add_f32 v10, v10, v34
v_mfma_f32_16x16x32_bf16 v[192:195], a[144:147], v[64:67], v[192:195]
v_exp_f32 v36, v36
v_mfma_f32_16x16x32_bf16 v[196:199], a[148:151], v[64:67], v[196:199]
ds_read_b64_tr_b16 a[136:137], v8 offset:17600
v_add_f32 v10, v10, v35
v_cvt_pk_bf16_f32 v57, v34, v35
v_mfma_f32_16x16x32_bf16 v[200:203], a[152:155], v[64:67], v[200:203]
v_exp_f32 v37, v37
v_mfma_f32_16x16x32_bf16 v[204:207], a[156:159], v[64:67], v[204:207]
ds_read_b64_tr_b16 a[138:139], v8 offset:21952
v_add_f32 v10, v10, v36
v_mfma_f32_16x16x32_bf16 v[208:211], a[160:163], v[64:67], v[208:211]
v_exp_f32 v38, v38
v_mfma_f32_16x16x32_bf16 v[212:215], a[164:167], v[64:67], v[212:215]
ds_read_b64_tr_b16 a[140:141], v9 offset:17600
v_add_f32 v10, v10, v37
v_cvt_pk_bf16_f32 v58, v36, v37
v_mfma_f32_16x16x32_bf16 v[216:219], a[168:171], v[64:67], v[216:219]
v_exp_f32 v39, v39
v_mfma_f32_16x16x32_bf16 v[220:223], a[172:175], v[64:67], v[220:223]
ds_read_b64_tr_b16 a[142:143], v9 offset:21952
v_add_f32 v10, v10, v38
v_mfma_f32_16x16x32_bf16 v[48:51], a[48:51], a[32:35], v[24:27]
v_exp_f32 v40, v40
v_mfma_f32_16x16x32_bf16 v[48:51], a[52:55], a[36:39], v[48:51]
ds_read_b128 a[80:83], v7 offset:8704
ds_read_b128 a[84:87], v7 offset:8768
v_add_f32 v10, v10, v39
v_cvt_pk_bf16_f32 v59, v38, v39
v_mfma_f32_16x16x32_bf16 v[48:51], a[56:59], a[40:43], v[48:51]
v_exp_f32 v41, v41
v_mfma_f32_16x16x32_bf16 v[48:51], a[60:63], a[44:47], v[48:51]
ds_read_b128 a[88:91], v7 offset:8832
v_add_f32 v11, v11, v40
s_add_u32 m0, s38, 121856
v_mfma_f32_16x16x32_bf16 v[52:55], a[64:67], a[32:35], v[24:27]
v_exp_f32 v42, v42
v_mfma_f32_16x16x32_bf16 v[52:55], a[68:71], a[36:39], v[52:55]
ds_read_b128 a[92:95], v7 offset:8896
v_add_f32 v11, v11, v41
v_cvt_pk_bf16_f32 v60, v40, v41
v_mfma_f32_16x16x32_bf16 v[52:55], a[72:75], a[40:43], v[52:55]
v_exp_f32 v43, v43
v_mfma_f32_16x16x32_bf16 v[52:55], a[76:79], a[44:47], v[52:55]
buffer_load_dwordx4 v72, s[28:31], s54 offen offset:0 sc1 nt lds
ds_read_b128 a[96:99], v7 offset:13056
ds_read_b128 a[100:103], v7 offset:13120
v_add_f32 v11, v11, v42
s_waitcnt lgkmcnt(6)
v_mfma_f32_16x16x32_bf16 v[128:131], a[112:115], v[56:59], v[128:131]
L_pg2:
s_cbranch_execz L_pg_done
v_exp_f32 v44, v44
v_mfma_f32_16x16x32_bf16 v[132:135], a[116:119], v[56:59], v[132:135]
ds_read_b128 a[104:107], v7 offset:13184
v_add_f32 v11, v11, v43
v_cvt_pk_bf16_f32 v61, v42, v43
v_mfma_f32_16x16x32_bf16 v[136:139], a[120:123], v[56:59], v[136:139]
v_exp_f32 v45, v45
v_mfma_f32_16x16x32_bf16 v[140:143], a[124:127], v[56:59], v[140:143]
ds_read_b128 a[108:111], v7 offset:13248
v_add_f32 v11, v11, v44
v_mfma_f32_16x16x32_bf16 v[144:147], a[128:131], v[56:59], v[144:147]
v_exp_f32 v46, v46
v_mfma_f32_16x16x32_bf16 v[148:151], a[132:135], v[56:59], v[148:151]
v_add_f32 v11, v11, v45
v_cvt_pk_bf16_f32 v62, v44, v45
v_mfma_f32_16x16x32_bf16 v[152:155], a[136:139], v[56:59], v[152:155]
v_exp_f32 v47, v47
v_mfma_f32_16x16x32_bf16 v[156:159], a[140:143], v[56:59], v[156:159]
buffer_load_dwordx4 v73, s[28:31], s54 offen offset:1088 sc1 nt lds
v_add_f32 v11, v11, v46
s_waitcnt lgkmcnt(0)
v_mfma_f32_16x16x32_bf16 v[32:35], a[80:83], a[0:3], v[16:19]
v_exp_f32 v48, v48
v_mfma_f32_16x16x32_bf16 v[32:35], a[84:87], a[4:7], v[32:35]
ds_read_b64_tr_b16 a[144:145], v8 offset:26112
v_add_f32 v11, v11, v47
v_cvt_pk_bf16_f32 v63, v46, v47
v_mfma_f32_16x16x32_bf16 v[32:35], a[88:91], a[8:11], v[32:35]
v_exp_f32 v49, v49
v_mfma_f32_16x16x32_bf16 v[32:35], a[92:95], a[12:15], v[32:35]
ds_read_b64_tr_b16 a[146:147], v8 offset:30464
v_add_f32 v12, v12, v48
v_mfma_f32_16x16x32_bf16 v[36:39], a[96:99], a[0:3], v[16:19]
v_exp_f32 v50, v50
v_mfma_f32_16x16x32_bf16 v[36:39], a[100:103], a[4:7], v[36:39]
ds_read_b64_tr_b16 a[148:149], v9 offset:26112
v_add_f32 v12, v12, v49
v_cvt_pk_bf16_f32 v64, v48, v49
v_mfma_f32_16x16x32_bf16 v[36:39], a[104:107], a[8:11], v[36:39]
v_exp_f32 v51, v51
v_mfma_f32_16x16x32_bf16 v[36:39], a[108:111], a[12:15], v[36:39]
ds_read_b64_tr_b16 a[150:151], v9 offset:30464
v_add_f32 v12, v12, v50
v_mfma_f32_16x16x32_bf16 v[160:163], a[112:115], v[60:63], v[160:163]
v_exp_f32 v52, v52
v_mfma_f32_16x16x32_bf16 v[164:167], a[116:119], v[60:63], v[164:167]
ds_read_b64_tr_b16 a[152:153], v8 offset:26176
v_add_f32 v12, v12, v51
v_cvt_pk_bf16_f32 v65, v50, v51
v_mfma_f32_16x16x32_bf16 v[168:171], a[120:123], v[60:63], v[168:171]
v_exp_f32 v53, v53
v_mfma_f32_16x16x32_bf16 v[172:175], a[124:127], v[60:63], v[172:175]
buffer_load_dwordx4 v74, s[28:31], s54 offen offset:2176 sc1 nt lds
ds_read_b64_tr_b16 a[154:155], v8 offset:30528
v_add_f32 v12, v12, v52
v_mfma_f32_16x16x32_bf16 v[176:179], a[128:131], v[60:63], v[176:179]
v_exp_f32 v54, v54
v_mfma_f32_16x16x32_bf16 v[180:183], a[132:135], v[60:63], v[180:183]
ds_read_b64_tr_b16 a[156:157], v9 offset:26176
v_add_f32 v12, v12, v53
v_cvt_pk_bf16_f32 v66, v52, v53
v_mfma_f32_16x16x32_bf16 v[184:187], a[136:139], v[60:63], v[184:187]
v_exp_f32 v55, v55
v_mfma_f32_16x16x32_bf16 v[188:191], a[140:143], v[60:63], v[188:191]
ds_read_b64_tr_b16 a[158:159], v9 offset:30528
v_add_f32 v12, v12, v54
v_mfma_f32_16x16x32_bf16 v[40:43], a[80:83], a[16:19], v[20:23]
v_exp_f32 v32, v32
v_mfma_f32_16x16x32_bf16 v[40:43], a[84:87], a[20:23], v[40:43]
ds_read_b64_tr_b16 a[160:161], v8 offset:26240
ds_read_b64_tr_b16 a[162:163], v8 offset:30592
v_add_f32 v12, v12, v55
v_cvt_pk_bf16_f32 v67, v54, v55
v_mfma_f32_16x16x32_bf16 v[40:43], a[88:91], a[24:27], v[40:43]
v_exp_f32 v33, v33
v_mfma_f32_16x16x32_bf16 v[40:43], a[92:95], a[28:31], v[40:43]
ds_read_b64_tr_b16 a[164:165], v9 offset:26240
v_add_f32 v10, v10, v32
v_mfma_f32_16x16x32_bf16 v[44:47], a[96:99], a[16:19], v[20:23]
v_exp_f32 v34, v34
v_mfma_f32_16x16x32_bf16 v[44:47], a[100:103], a[20:23], v[44:47]
ds_read_b64_tr_b16 a[166:167], v9 offset:30592
v_add_f32 v10, v10, v33
v_cvt_pk_bf16_f32 v56, v32, v33
v_mfma_f32_16x16x32_bf16 v[44:47], a[104:107], a[24:27], v[44:47]
v_exp_f32 v35, v35
v_mfma_f32_16x16x32_bf16 v[44:47], a[108:111], a[28:31], v[44:47]
buffer_load_dwordx4 v75, s[28:31], s54 offen offset:3264 sc1 nt lds
ds_read_b64_tr_b16 a[168:169], v8 offset:26304
ds_read_b64_tr_b16 a[170:171], v8 offset:30656
v_add_f32 v10, v10, v34
v_mfma_f32_16x16x32_bf16 v[192:195], a[112:115], v[64:67], v[192:195]
v_exp_f32 v36, v36
v_mfma_f32_16x16x32_bf16 v[196:199], a[116:119], v[64:67], v[196:199]
ds_read_b64_tr_b16 a[172:173], v9 offset:26304
v_add_f32 v10, v10, v35
v_cvt_pk_bf16_f32 v57, v34, v35
v_mfma_f32_16x16x32_bf16 v[200:203], a[120:123], v[64:67], v[200:203]
v_exp_f32 v37, v37
v_mfma_f32_16x16x32_bf16 v[204:207], a[124:127], v[64:67], v[204:207]
ds_read_b64_tr_b16 a[174:175], v9 offset:30656
v_add_f32 v10, v10, v36
v_mfma_f32_16x16x32_bf16 v[208:211], a[128:131], v[64:67], v[208:211]
v_exp_f32 v38, v38
v_mfma_f32_16x16x32_bf16 v[212:215], a[132:135], v[64:67], v[212:215]
v_add_f32 v10, v10, v37
v_cvt_pk_bf16_f32 v58, v36, v37
v_add_u32 v7, 34816, v4
v_add_u32 v8, 34816, v5
v_add_u32 v9, 34816, v6
v_mfma_f32_16x16x32_bf16 v[216:219], a[136:139], v[64:67], v[216:219]
v_exp_f32 v39, v39
v_mfma_f32_16x16x32_bf16 v[220:223], a[140:143], v[64:67], v[220:223]
s_waitcnt vmcnt(16) lgkmcnt(0)
s_barrier
v_add_f32 v10, v10, v38
v_mfma_f32_16x16x32_bf16 v[48:51], a[80:83], a[32:35], v[24:27]
v_exp_f32 v40, v40
v_mfma_f32_16x16x32_bf16 v[48:51], a[84:87], a[36:39], v[48:51]
ds_read_b128 a[48:51], v7 offset:0
ds_read_b128 a[52:55], v7 offset:64
v_add_f32 v10, v10, v39
v_cvt_pk_bf16_f32 v59, v38, v39
v_mfma_f32_16x16x32_bf16 v[48:51], a[88:91], a[40:43], v[48:51]
v_exp_f32 v41, v41
v_mfma_f32_16x16x32_bf16 v[48:51], a[92:95], a[44:47], v[48:51]
ds_read_b128 a[56:59], v7 offset:128
v_add_f32 v11, v11, v40
v_mfma_f32_16x16x32_bf16 v[52:55], a[96:99], a[32:35], v[24:27]
v_exp_f32 v42, v42
v_mfma_f32_16x16x32_bf16 v[52:55], a[100:103], a[36:39], v[52:55]
ds_read_b128 a[60:63], v7 offset:192
v_add_f32 v11, v11, v41
v_cvt_pk_bf16_f32 v60, v40, v41
v_mfma_f32_16x16x32_bf16 v[52:55], a[104:107], a[40:43], v[52:55]
v_exp_f32 v43, v43
v_mfma_f32_16x16x32_bf16 v[52:55], a[108:111], a[44:47], v[52:55]
ds_read_b128 a[64:67], v7 offset:4352
ds_read_b128 a[68:71], v7 offset:4416
v_add_f32 v11, v11, v42
v_mfma_f32_16x16x32_bf16 v[128:131], a[144:147], v[56:59], v[128:131]
v_exp_f32 v44, v44
v_mfma_f32_16x16x32_bf16 v[132:135], a[148:151], v[56:59], v[132:135]
ds_read_b128 a[72:75], v7 offset:4480
v_add_f32 v11, v11, v43
v_cvt_pk_bf16_f32 v61, v42, v43
v_mfma_f32_16x16x32_bf16 v[136:139], a[152:155], v[56:59], v[136:139]
v_exp_f32 v45, v45
v_mfma_f32_16x16x32_bf16 v[140:143], a[156:159], v[56:59], v[140:143]
ds_read_b128 a[76:79], v7 offset:4544
v_add_f32 v11, v11, v44
v_mfma_f32_16x16x32_bf16 v[144:147], a[160:163], v[56:59], v[144:147]
v_exp_f32 v46, v46
v_mfma_f32_16x16x32_bf16 v[148:151], a[164:167], v[56:59], v[148:151]
v_add_f32 v11, v11, v45
v_cvt_pk_bf16_f32 v62, v44, v45
v_mfma_f32_16x16x32_bf16 v[152:155], a[168:171], v[56:59], v[152:155]
v_exp_f32 v47, v47
v_mfma_f32_16x16x32_bf16 v[156:159], a[172:175], v[56:59], v[156:159]
v_add_f32 v11, v11, v46
s_waitcnt lgkmcnt(0)
v_mfma_f32_16x16x32_bf16 v[32:35], a[48:51], a[0:3], v[16:19]
v_exp_f32 v48, v48
v_mfma_f32_16x16x32_bf16 v[32:35], a[52:55], a[4:7], v[32:35]
ds_read_b64_tr_b16 a[112:113], v8 offset:17408
v_add_f32 v11, v11, v47
v_cvt_pk_bf16_f32 v63, v46, v47
v_mfma_f32_16x16x32_bf16 v[32:35], a[56:59], a[8:11], v[32:35]
v_exp_f32 v49, v49
v_mfma_f32_16x16x32_bf16 v[32:35], a[60:63], a[12:15], v[32:35]
ds_read_b64_tr_b16 a[114:115], v8 offset:21760
v_add_f32 v12, v12, v48
v_mfma_f32_16x16x32_bf16 v[36:39], a[64:67], a[0:3], v[16:19]
v_exp_f32 v50, v50
v_mfma_f32_16x16x32_bf16 v[36:39], a[68:71], a[4:7], v[36:39]
ds_read_b64_tr_b16 a[116:117], v9 offset:17408
v_add_f32 v12, v12, v49
v_cvt_pk_bf16_f32 v64, v48, v49
v_mfma_f32_16x16x32_bf16 v[36:39], a[72:75], a[8:11], v[36:39]
v_exp_f32 v51, v51
v_mfma_f32_16x16x32_bf16 v[36:39], a[76:79], a[12:15], v[36:39]
ds_read_b64_tr_b16 a[118:119], v9 offset:21760
v_add_f32 v12, v12, v50
v_mfma_f32_16x16x32_bf16 v[160:163], a[144:147], v[60:63], v[160:163]
v_exp_f32 v52, v52
v_mfma_f32_16x16x32_bf16 v[164:167], a[148:151], v[60:63], v[164:167]
ds_read_b64_tr_b16 a[120:121], v8 offset:17472
v_add_f32 v12, v12, v51
v_cvt_pk_bf16_f32 v65, v50, v51
v_mfma_f32_16x16x32_bf16 v[168:171], a[152:155], v[60:63], v[168:171]
v_exp_f32 v53, v53
v_mfma_f32_16x16x32_bf16 v[172:175], a[156:159], v[60:63], v[172:175]
ds_read_b64_tr_b16 a[122:123], v8 offset:21824
v_add_f32 v12, v12, v52
v_mfma_f32_16x16x32_bf16 v[176:179], a[160:163], v[60:63], v[176:179]
v_exp_f32 v54, v54
v_mfma_f32_16x16x32_bf16 v[180:183], a[164:167], v[60:63], v[180:183]
ds_read_b64_tr_b16 a[124:125], v9 offset:17472
v_add_f32 v12, v12, v53
v_cvt_pk_bf16_f32 v66, v52, v53
v_mfma_f32_16x16x32_bf16 v[184:187], a[168:171], v[60:63], v[184:187]
v_exp_f32 v55, v55
v_mfma_f32_16x16x32_bf16 v[188:191], a[172:175], v[60:63], v[188:191]
ds_read_b64_tr_b16 a[126:127], v9 offset:21824
v_add_f32 v12, v12, v54
v_mfma_f32_16x16x32_bf16 v[40:43], a[48:51], a[16:19], v[20:23]
v_exp_f32 v32, v32
v_mfma_f32_16x16x32_bf16 v[40:43], a[52:55], a[20:23], v[40:43]
ds_read_b64_tr_b16 a[128:129], v8 offset:17536
v_add_f32 v12, v12, v55
v_cvt_pk_bf16_f32 v67, v54, v55
v_mfma_f32_16x16x32_bf16 v[40:43], a[56:59], a[24:27], v[40:43]
v_exp_f32 v33, v33
v_mfma_f32_16x16x32_bf16 v[40:43], a[60:63], a[28:31], v[40:43]
ds_read_b64_tr_b16 a[130:131], v8 offset:21888
v_add_f32 v10, v10, v32
v_mfma_f32_16x16x32_bf16 v[44:47], a[64:67], a[16:19], v[20:23]
v_exp_f32 v34, v34
v_mfma_f32_16x16x32_bf16 v[44:47], a[68:71], a[20:23], v[44:47]
ds_read_b64_tr_b16 a[132:133], v9 offset:17536
v_add_f32 v10, v10, v33
v_cvt_pk_bf16_f32 v56, v32, v33
v_mfma_f32_16x16x32_bf16 v[44:47], a[72:75], a[24:27], v[44:47]
v_exp_f32 v35, v35
v_mfma_f32_16x16x32_bf16 v[44:47], a[76:79], a[28:31], v[44:47]
ds_read_b64_tr_b16 a[134:135], v9 offset:21888
v_add_f32 v10, v10, v34
v_mfma_f32_16x16x32_bf16 v[192:195], a[144:147], v[64:67], v[192:195]
v_exp_f32 v36, v36
v_mfma_f32_16x16x32_bf16 v[196:199], a[148:151], v[64:67], v[196:199]
ds_read_b64_tr_b16 a[136:137], v8 offset:17600
v_add_f32 v10, v10, v35
v_cvt_pk_bf16_f32 v57, v34, v35
v_mfma_f32_16x16x32_bf16 v[200:203], a[152:155], v[64:67], v[200:203]
v_exp_f32 v37, v37
v_mfma_f32_16x16x32_bf16 v[204:207], a[156:159], v[64:67], v[204:207]
ds_read_b64_tr_b16 a[138:139], v8 offset:21952
v_add_f32 v10, v10, v36
v_mfma_f32_16x16x32_bf16 v[208:211], a[160:163], v[64:67], v[208:211]
v_exp_f32 v38, v38
v_mfma_f32_16x16x32_bf16 v[212:215], a[164:167], v[64:67], v[212:215]
ds_read_b64_tr_b16 a[140:141], v9 offset:17600
v_add_f32 v10, v10, v37
v_cvt_pk_bf16_f32 v58, v36, v37
v_mfma_f32_16x16x32_bf16 v[216:219], a[168:171], v[64:67], v[216:219]
v_exp_f32 v39, v39
v_mfma_f32_16x16x32_bf16 v[220:223], a[172:175], v[64:67], v[220:223]
ds_read_b64_tr_b16 a[142:143], v9 offset:21952
v_add_f32 v10, v10, v38
v_mfma_f32_16x16x32_bf16 v[48:51], a[48:51], a[32:35], v[24:27]
v_exp_f32 v40, v40
v_mfma_f32_16x16x32_bf16 v[48:51], a[52:55], a[36:39], v[48:51]
ds_read_b128 a[80:83], v7 offset:8704
ds_read_b128 a[84:87], v7 offset:8768
v_add_f32 v10, v10, v39
v_cvt_pk_bf16_f32 v59, v38, v39
v_mfma_f32_16x16x32_bf16 v[48:51], a[56:59], a[40:43], v[48:51]
v_exp_f32 v41, v41
v_mfma_f32_16x16x32_bf16 v[48:51], a[60:63], a[44:47], v[48:51]
ds_read_b128 a[88:91], v7 offset:8832
v_add_f32 v11, v11, v40
v_mfma_f32_16x16x32_bf16 v[52:55], a[64:67], a[32:35], v[24:27]
v_exp_f32 v42, v42
v_mfma_f32_16x16x32_bf16 v[52:55], a[68:71], a[36:39], v[52:55]
ds_read_b128 a[92:95], v7 offset:8896
v_add_f32 v11, v11, v41
v_cvt_pk_bf16_f32 v60, v40, v41
v_mfma_f32_16x16x32_bf16 v[52:55], a[72:75], a[40:43], v[52:55]
v_exp_f32 v43, v43
v_mfma_f32_16x16x32_bf16 v[52:55], a[76:79], a[44:47], v[52:55]
ds_read_b128 a[96:99], v7 offset:13056
ds_read_b128 a[100:103], v7 offset:13120
v_add_f32 v11, v11, v42
s_waitcnt lgkmcnt(6)
v_mfma_f32_16x16x32_bf16 v[128:131], a[112:115], v[56:59], v[128:131]
v_exp_f32 v44, v44
v_mfma_f32_16x16x32_bf16 v[132:135], a[116:119], v[56:59], v[132:135]
ds_read_b128 a[104:107], v7 offset:13184
v_add_f32 v11, v11, v43
v_cvt_pk_bf16_f32 v61, v42, v43
v_mfma_f32_16x16x32_bf16 v[136:139], a[120:123], v[56:59], v[136:139]
v_exp_f32 v45, v45
v_mfma_f32_16x16x32_bf16 v[140:143], a[124:127], v[56:59], v[140:143]
ds_read_b128 a[108:111], v7 offset:13248
v_add_f32 v11, v11, v44
v_mfma_f32_16x16x32_bf16 v[144:147], a[128:131], v[56:59], v[144:147]
v_exp_f32 v46, v46
v_mfma_f32_16x16x32_bf16 v[148:151], a[132:135], v[56:59], v[148:151]
v_add_f32 v11, v11, v45
v_cvt_pk_bf16_f32 v62, v44, v45
v_mfma_f32_16x16x32_bf16 v[152:155], a[136:139], v[56:59], v[152:155]
v_exp_f32 v47, v47
v_mfma_f32_16x16x32_bf16 v[156:159], a[140:143], v[56:59], v[156:159]
v_add_f32 v11, v11, v46
s_waitcnt lgkmcnt(0)
v_mfma_f32_16x16x32_bf16 v[32:35], a[80:83], a[0:3], v[16:19]
v_exp_f32 v48, v48
v_mfma_f32_16x16x32_bf16 v[32:35], a[84:87], a[4:7], v[32:35]
ds_read_b64_tr_b16 a[144:145], v8 offset:26112
v_add_f32 v11, v11, v47
v_cvt_pk_bf16_f32 v63, v46, v47
v_mfma_f32_16x16x32_bf16 v[32:35], a[88:91], a[8:11], v[32:35]
v_exp_f32 v49, v49
v_mfma_f32_16x16x32_bf16 v[32:35], a[92:95], a[12:15], v[32:35]
ds_read_b64_tr_b16 a[146:147], v8 offset:30464
v_add_f32 v12, v12, v48
v_mfma_f32_16x16x32_bf16 v[36:39], a[96:99], a[0:3], v[16:19]
v_exp_f32 v50, v50
v_mfma_f32_16x16x32_bf16 v[36:39], a[100:103], a[4:7], v[36:39]
ds_read_b64_tr_b16 a[148:149], v9 offset:26112
v_add_f32 v12, v12, v49
v_cvt_pk_bf16_f32 v64, v48, v49
v_mfma_f32_16x16x32_bf16 v[36:39], a[104:107], a[8:11], v[36:39]
v_exp_f32 v51, v51
v_mfma_f32_16x16x32_bf16 v[36:39], a[108:111], a[12:15], v[36:39]
ds_read_b64_tr_b16 a[150:151], v9 offset:30464
v_add_f32 v12, v12, v50
v_mfma_f32_16x16x32_bf16 v[160:163], a[112:115], v[60:63], v[160:163]
v_exp_f32 v52, v52
v_mfma_f32_16x16x32_bf16 v[164:167], a[116:119], v[60:63], v[164:167]
ds_read_b64_tr_b16 a[152:153], v8 offset:26176
v_add_f32 v12, v12, v51
v_cvt_pk_bf16_f32 v65, v50, v51
v_mfma_f32_16x16x32_bf16 v[168:171], a[120:123], v[60:63], v[168:171]
v_exp_f32 v53, v53
v_mfma_f32_16x16x32_bf16 v[172:175], a[124:127], v[60:63], v[172:175]
ds_read_b64_tr_b16 a[154:155], v8 offset:30528
v_add_f32 v12, v12, v52
v_mfma_f32_16x16x32_bf16 v[176:179], a[128:131], v[60:63], v[176:179]
v_exp_f32 v54, v54
v_mfma_f32_16x16x32_bf16 v[180:183], a[132:135], v[60:63], v[180:183]
ds_read_b64_tr_b16 a[156:157], v9 offset:26176
v_add_f32 v12, v12, v53
v_cvt_pk_bf16_f32 v66, v52, v53
v_mfma_f32_16x16x32_bf16 v[184:187], a[136:139], v[60:63], v[184:187]
v_exp_f32 v55, v55
v_mfma_f32_16x16x32_bf16 v[188:191], a[140:143], v[60:63], v[188:191]
ds_read_b64_tr_b16 a[158:159], v9 offset:30528
v_add_f32 v12, v12, v54
v_mfma_f32_16x16x32_bf16 v[40:43], a[80:83], a[16:19], v[20:23]
v_exp_f32 v32, v32
v_mfma_f32_16x16x32_bf16 v[40:43], a[84:87], a[20:23], v[40:43]
ds_read_b64_tr_b16 a[160:161], v8 offset:26240
ds_read_b64_tr_b16 a[162:163], v8 offset:30592
v_add_f32 v12, v12, v55
v_cvt_pk_bf16_f32 v67, v54, v55
v_mfma_f32_16x16x32_bf16 v[40:43], a[88:91], a[24:27], v[40:43]
v_exp_f32 v33, v33
v_mfma_f32_16x16x32_bf16 v[40:43], a[92:95], a[28:31], v[40:43]
ds_read_b64_tr_b16 a[164:165], v9 offset:26240
v_add_f32 v10, v10, v32
v_mfma_f32_16x16x32_bf16 v[44:47], a[96:99], a[16:19], v[20:23]
v_exp_f32 v34, v34
v_mfma_f32_16x16x32_bf16 v[44:47], a[100:103], a[20:23], v[44:47]
ds_read_b64_tr_b16 a[166:167], v9 offset:30592
v_add_f32 v10, v10, v33
v_cvt_pk_bf16_f32 v56, v32, v33
v_mfma_f32_16x16x32_bf16 v[44:47], a[104:107], a[24:27], v[44:47]
v_exp_f32 v35, v35
v_mfma_f32_16x16x32_bf16 v[44:47], a[108:111], a[28:31], v[44:47]
ds_read_b64_tr_b16 a[168:169], v8 offset:26304
ds_read_b64_tr_b16 a[170:171], v8 offset:30656
v_add_f32 v10, v10, v34
v_mfma_f32_16x16x32_bf16 v[192:195], a[112:115], v[64:67], v[192:195]
v_exp_f32 v36, v36
v_mfma_f32_16x16x32_bf16 v[196:199], a[116:119], v[64:67], v[196:199]
ds_read_b64_tr_b16 a[172:173], v9 offset:26304
v_add_f32 v10, v10, v35
v_cvt_pk_bf16_f32 v57, v34, v35
v_mfma_f32_16x16x32_bf16 v[200:203], a[120:123], v[64:67], v[200:203]
v_exp_f32 v37, v37
v_mfma_f32_16x16x32_bf16 v[204:207], a[124:127], v[64:67], v[204:207]
ds_read_b64_tr_b16 a[174:175], v9 offset:30656
v_add_f32 v10, v10, v36
v_mfma_f32_16x16x32_bf16 v[208:211], a[128:131], v[64:67], v[208:211]
v_exp_f32 v38, v38
v_mfma_f32_16x16x32_bf16 v[212:215], a[132:135], v[64:67], v[212:215]
v_add_f32 v10, v10, v37
v_cvt_pk_bf16_f32 v58, v36, v37
v_add_u32 v7, 69632, v4
v_add_u32 v8, 69632, v5
v_add_u32 v9, 69632, v6
v_mfma_f32_16x16x32_bf16 v[216:219], a[136:139], v[64:67], v[216:219]
v_exp_f32 v39, v39
v_mfma_f32_16x16x32_bf16 v[220:223], a[140:143], v[64:67], v[220:223]
s_waitcnt vmcnt(0) lgkmcnt(0)
s_barrier
v_add_f32 v10, v10, v38
v_mfma_f32_16x16x32_bf16 v[48:51], a[80:83], a[32:35], v[24:27]
v_exp_f32 v40, v40
v_mfma_f32_16x16x32_bf16 v[48:51], a[84:87], a[36:39], v[48:51]
ds_read_b128 a[48:51], v7 offset:0
ds_read_b128 a[52:55], v7 offset:64
v_add_f32 v10, v10, v39
v_cvt_pk_bf16_f32 v59, v38, v39
s_mul_i32 s46, s16, 13056
v_and_b32 v28, 15, v0
v_mfma_f32_16x16x32_bf16 v[48:51], a[88:91], a[40:43], v[48:51]
v_exp_f32 v41, v41
v_mfma_f32_16x16x32_bf16 v[48:51], a[92:95], a[44:47], v[48:51]
ds_read_b128 a[56:59], v7 offset:128
ds_read_b128 a[60:63], v7 offset:192
v_add_f32 v11, v11, v40
v_lshrrev_b32 v29, 4, v0
v_mul_u32_u24 v76, 272, v28
v_mfma_f32_16x16x32_bf16 v[52:55], a[96:99], a[32:35], v[24:27]
v_exp_f32 v42, v42
v_mfma_f32_16x16x32_bf16 v[52:55], a[100:103], a[36:39], v[52:55]
ds_read_b128 a[64:67], v7 offset:4352
ds_read_b128 a[68:71], v7 offset:4416
v_add_f32 v11, v11, v41
v_cvt_pk_bf16_f32 v60, v40, v41
v_mul_u32_u24 v77, 272, v29
v_lshlrev_b32 v29, 3, v29
v_mfma_f32_16x16x32_bf16 v[52:55], a[104:107], a[40:43], v[52:55]
v_exp_f32 v43, v43
v_mfma_f32_16x16x32_bf16 v[52:55], a[108:111], a[44:47], v[52:55]
ds_read_b128 a[72:75], v7 offset:4480
ds_read_b128 a[76:79], v7 offset:4544
v_add_f32 v11, v11, v42
v_lshlrev_b32 v28, 4, v28
v_add3_u32 v76, v76, v29, s46
v_mfma_f32_16x16x32_bf16 v[128:131], a[144:147], v[56:59], v[128:131]
v_exp_f32 v44, v44
v_mfma_f32_16x16x32_bf16 v[132:135], a[148:151], v[56:59], v[132:135]
ds_read_b64_tr_b16 a[112:113], v8 offset:17408
ds_read_b64_tr_b16 a[114:115], v8 offset:21760
v_add_f32 v11, v11, v43
v_cvt_pk_bf16_f32 v61, v42, v43
v_add3_u32 v77, v77, v28, s46
v_lshlrev_b32 v78, 4, v0
v_mfma_f32_16x16x32_bf16 v[136:139], a[152:155], v[56:59], v[136:139]
v_exp_f32 v45, v45
v_mfma_f32_16x16x32_bf16 v[140:143], a[156:159], v[56:59], v[140:143]
ds_read_b64_tr_b16 a[116:117], v9 offset:17408
ds_read_b64_tr_b16 a[118:119], v9 offset:21760
v_add_f32 v11, v11, v44
v_mfma_f32_16x16x32_bf16 v[144:147], a[160:163], v[56:59], v[144:147]
v_exp_f32 v46, v46
v_mfma_f32_16x16x32_bf16 v[148:151], a[164:167], v[56:59], v[148:151]
ds_read_b64_tr_b16 a[120:121], v8 offset:17472
ds_read_b64_tr_b16 a[122:123], v8 offset:21824
v_add_f32 v11, v11, v45
v_cvt_pk_bf16_f32 v62, v44, v45
v_mfma_f32_16x16x32_bf16 v[152:155], a[168:171], v[56:59], v[152:155]
v_exp_f32 v47, v47
v_mfma_f32_16x16x32_bf16 v[156:159], a[172:175], v[56:59], v[156:159]
ds_read_b64_tr_b16 a[124:125], v9 offset:17472
ds_read_b64_tr_b16 a[126:127], v9 offset:21824
v_add_f32 v11, v11, v46
s_waitcnt lgkmcnt(8)
v_mfma_f32_16x16x32_bf16 v[32:35], a[48:51], a[0:3], v[16:19]
v_exp_f32 v48, v48
v_mfma_f32_16x16x32_bf16 v[32:35], a[52:55], a[4:7], v[32:35]
ds_read_b128 a[176:179], v7 offset:8704
ds_read_b128 a[180:183], v7 offset:8768
v_add_f32 v11, v11, v47
v_cvt_pk_bf16_f32 v63, v46, v47
v_mfma_f32_16x16x32_bf16 v[32:35], a[56:59], a[8:11], v[32:35]
v_exp_f32 v49, v49
v_mfma_f32_16x16x32_bf16 v[32:35], a[60:63], a[12:15], v[32:35]
ds_read_b128 a[184:187], v7 offset:8832
ds_read_b128 a[188:191], v7 offset:8896
v_add_f32 v12, v12, v48
v_mfma_f32_16x16x32_bf16 v[36:39], a[64:67], a[0:3], v[16:19]
v_exp_f32 v50, v50
v_mfma_f32_16x16x32_bf16 v[36:39], a[68:71], a[4:7], v[36:39]
ds_read_b128 a[192:195], v7 offset:13056
ds_read_b128 a[196:199], v7 offset:13120
v_add_f32 v12, v12, v49
v_cvt_pk_bf16_f32 v64, v48, v49
v_mfma_f32_16x16x32_bf16 v[36:39], a[72:75], a[8:11], v[36:39]
v_exp_f32 v51, v51
v_mfma_f32_16x16x32_bf16 v[36:39], a[76:79], a[12:15], v[36:39]
ds_read_b128 a[200:203], v7 offset:13184
ds_read_b128 a[204:207], v7 offset:13248
v_add_f32 v12, v12, v50
v_mfma_f32_16x16x32_bf16 v[160:163], a[144:147], v[60:63], v[160:163]
v_exp_f32 v52, v52
v_mfma_f32_16x16x32_bf16 v[164:167], a[148:151], v[60:63], v[164:167]
ds_read_b64_tr_b16 a[128:129], v8 offset:17536
ds_read_b64_tr_b16 a[130:131], v8 offset:21888
v_add_f32 v12, v12, v51
v_cvt_pk_bf16_f32 v65, v50, v51
v_mfma_f32_16x16x32_bf16 v[168:171], a[152:155], v[60:63], v[168:171]
v_exp_f32 v53, v53
v_mfma_f32_16x16x32_bf16 v[172:175], a[156:159], v[60:63], v[172:175]
ds_read_b64_tr_b16 a[132:133], v9 offset:17536
ds_read_b64_tr_b16 a[134:135], v9 offset:21888
v_add_f32 v12, v12, v52
v_mfma_f32_16x16x32_bf16 v[176:179], a[160:163], v[60:63], v[176:179]
v_exp_f32 v54, v54
v_mfma_f32_16x16x32_bf16 v[180:183], a[164:167], v[60:63], v[180:183]
ds_read_b64_tr_b16 a[136:137], v8 offset:17600
ds_read_b64_tr_b16 a[138:139], v8 offset:21952
v_add_f32 v12, v12, v53
v_cvt_pk_bf16_f32 v66, v52, v53
v_mfma_f32_16x16x32_bf16 v[184:187], a[168:171], v[60:63], v[184:187]
v_exp_f32 v55, v55
v_mfma_f32_16x16x32_bf16 v[188:191], a[172:175], v[60:63], v[188:191]
ds_read_b64_tr_b16 a[140:141], v9 offset:17600
ds_read_b64_tr_b16 a[142:143], v9 offset:21952
v_add_f32 v12, v12, v54
s_waitcnt lgkmcnt(8)
v_mfma_f32_16x16x32_bf16 v[40:43], a[176:179], a[0:3], v[16:19]
v_exp_f32 v32, v32
v_mfma_f32_16x16x32_bf16 v[40:43], a[180:183], a[4:7], v[40:43]
ds_read_b128 a[208:211], v7 offset:34816
ds_read_b128 a[212:215], v7 offset:34880
v_add_f32 v12, v12, v55
v_cvt_pk_bf16_f32 v67, v54, v55
v_mfma_f32_16x16x32_bf16 v[40:43], a[184:187], a[8:11], v[40:43]
v_exp_f32 v33, v33
v_mfma_f32_16x16x32_bf16 v[40:43], a[188:191], a[12:15], v[40:43]
ds_read_b128 a[216:219], v7 offset:34944
ds_read_b128 a[220:223], v7 offset:35008
v_add_f32 v10, v10, v32
v_mfma_f32_16x16x32_bf16 v[44:47], a[192:195], a[0:3], v[16:19]
v_exp_f32 v34, v34
v_mfma_f32_16x16x32_bf16 v[44:47], a[196:199], a[4:7], v[44:47]
ds_read_b128 a[224:227], v7 offset:39168
ds_read_b128 a[228:231], v7 offset:39232
v_add_f32 v10, v10, v33
v_cvt_pk_bf16_f32 v56, v32, v33
v_mfma_f32_16x16x32_bf16 v[44:47], a[200:203], a[8:11], v[44:47]
v_exp_f32 v35, v35
v_mfma_f32_16x16x32_bf16 v[44:47], a[204:207], a[12:15], v[44:47]
ds_read_b128 a[232:235], v7 offset:39296
ds_read_b128 a[236:239], v7 offset:39360
v_add_f32 v10, v10, v34
v_mfma_f32_16x16x32_bf16 v[192:195], a[144:147], v[64:67], v[192:195]
v_exp_f32 v36, v36
v_mfma_f32_16x16x32_bf16 v[196:199], a[148:151], v[64:67], v[196:199]
ds_read_b64_tr_b16 v[224:225], v8 offset:26112
ds_read_b64_tr_b16 v[226:227], v8 offset:30464
v_add_f32 v10, v10, v35
v_cvt_pk_bf16_f32 v57, v34, v35
v_mfma_f32_16x16x32_bf16 v[200:203], a[152:155], v[64:67], v[200:203]
v_exp_f32 v37, v37
v_mfma_f32_16x16x32_bf16 v[204:207], a[156:159], v[64:67], v[204:207]
ds_read_b64_tr_b16 v[228:229], v9 offset:26112
ds_read_b64_tr_b16 v[230:231], v9 offset:30464
v_add_f32 v10, v10, v36
v_mfma_f32_16x16x32_bf16 v[208:211], a[160:163], v[64:67], v[208:211]
v_exp_f32 v38, v38
v_mfma_f32_16x16x32_bf16 v[212:215], a[164:167], v[64:67], v[212:215]
ds_read_b64_tr_b16 v[232:233], v8 offset:26176
ds_read_b64_tr_b16 v[234:235], v8 offset:30528
v_add_f32 v10, v10, v37
v_cvt_pk_bf16_f32 v58, v36, v37
v_mfma_f32_16x16x32_bf16 v[216:219], a[168:171], v[64:67], v[216:219]
v_exp_f32 v39, v39
v_mfma_f32_16x16x32_bf16 v[220:223], a[172:175], v[64:67], v[220:223]
ds_read_b64_tr_b16 v[236:237], v9 offset:26176
ds_read_b64_tr_b16 v[238:239], v9 offset:30528
v_add_f32 v10, v10, v38
s_waitcnt lgkmcnt(8)
v_mfma_f32_16x16x32_bf16 v[48:51], a[208:211], a[0:3], v[16:19]
v_exp_f32 v40, v40
v_mfma_f32_16x16x32_bf16 v[48:51], a[212:215], a[4:7], v[48:51]
ds_read_b128 a[80:83], v7 offset:43520
ds_read_b128 a[84:87], v7 offset:43584
v_add_f32 v10, v10, v39
v_cvt_pk_bf16_f32 v59, v38, v39
v_mfma_f32_16x16x32_bf16 v[48:51], a[216:219], a[8:11], v[48:51]
v_exp_f32 v41, v41
v_mfma_f32_16x16x32_bf16 v[48:51], a[220:223], a[12:15], v[48:51]
ds_read_b128 a[88:91], v7 offset:43648
ds_read_b128 a[92:95], v7 offset:43712
v_add_f32 v10, v10, v40
v_mfma_f32_16x16x32_bf16 v[52:55], a[224:227], a[0:3], v[16:19]
v_exp_f32 v42, v42
v_mfma_f32_16x16x32_bf16 v[52:55], a[228:231], a[4:7], v[52:55]
ds_read_b128 a[96:99], v7 offset:47872
ds_read_b128 a[100:103], v7 offset:47936
v_add_f32 v10, v10, v41
v_cvt_pk_bf16_f32 v60, v40, v41
v_mfma_f32_16x16x32_bf16 v[52:55], a[232:235], a[8:11], v[52:55]
v_exp_f32 v43, v43
v_mfma_f32_16x16x32_bf16 v[52:55], a[236:239], a[12:15], v[52:55]
ds_read_b128 a[104:107], v7 offset:48000
ds_read_b128 a[108:111], v7 offset:48064
v_add_f32 v10, v10, v42
v_mfma_f32_16x16x32_bf16 v[128:131], a[112:115], v[56:59], v[128:131]
v_exp_f32 v44, v44
v_mfma_f32_16x16x32_bf16 v[132:135], a[116:119], v[56:59], v[132:135]
ds_read_b64_tr_b16 v[240:241], v8 offset:26240
ds_read_b64_tr_b16 v[242:243], v8 offset:30592
v_add_f32 v10, v10, v43
v_cvt_pk_bf16_f32 v61, v42, v43
v_mfma_f32_16x16x32_bf16 v[136:139], a[120:123], v[56:59], v[136:139]
v_exp_f32 v45, v45
v_mfma_f32_16x16x32_bf16 v[140:143], a[124:127], v[56:59], v[140:143]
ds_read_b64_tr_b16 v[244:245], v9 offset:26240
ds_read_b64_tr_b16 v[246:247], v9 offset:30592
v_add_f32 v10, v10, v44
v_mfma_f32_16x16x32_bf16 v[144:147], a[128:131], v[56:59], v[144:147]
v_exp_f32 v46, v46
v_mfma_f32_16x16x32_bf16 v[148:151], a[132:135], v[56:59], v[148:151]
ds_read_b64_tr_b16 v[248:249], v8 offset:26304
ds_read_b64_tr_b16 v[250:251], v8 offset:30656
v_add_f32 v10, v10, v45
v_cvt_pk_bf16_f32 v62, v44, v45
v_mfma_f32_16x16x32_bf16 v[152:155], a[136:139], v[56:59], v[152:155]
v_exp_f32 v47, v47
v_mfma_f32_16x16x32_bf16 v[156:159], a[140:143], v[56:59], v[156:159]
ds_read_b64_tr_b16 v[252:253], v9 offset:26304
ds_read_b64_tr_b16 v[254:255], v9 offset:30656
v_add_f32 v10, v10, v46
s_waitcnt lgkmcnt(8)
v_mfma_f32_16x16x32_bf16 v[32:35], a[80:83], a[0:3], v[16:19]
v_exp_f32 v48, v48
v_mfma_f32_16x16x32_bf16 v[32:35], a[84:87], a[4:7], v[32:35]
ds_read_b64_tr_b16 v[96:97], v8 offset:52224
ds_read_b64_tr_b16 v[98:99], v8 offset:56576
v_add_f32 v10, v10, v47
v_cvt_pk_bf16_f32 v63, v46, v47
v_mfma_f32_16x16x32_bf16 v[32:35], a[88:91], a[8:11], v[32:35]
v_exp_f32 v49, v49
v_mfma_f32_16x16x32_bf16 v[32:35], a[92:95], a[12:15], v[32:35]
ds_read_b64_tr_b16 v[100:101], v9 offset:52224
ds_read_b64_tr_b16 v[102:103], v9 offset:56576
L_pg3:
s_cbranch_execz L_pg_done
v_add_f32 v10, v10, v48
v_mfma_f32_16x16x32_bf16 v[36:39], a[96:99], a[0:3], v[16:19]
v_exp_f32 v50, v50
v_mfma_f32_16x16x32_bf16 v[36:39], a[100:103], a[4:7], v[36:39]
ds_read_b64_tr_b16 v[104:105], v8 offset:52288
ds_read_b64_tr_b16 v[106:107], v8 offset:56640
v_add_f32 v10, v10, v49
v_cvt_pk_bf16_f32 v64, v48, v49
v_mfma_f32_16x16x32_bf16 v[36:39], a[104:107], a[8:11], v[36:39]
v_exp_f32 v51, v51
v_mfma_f32_16x16x32_bf16 v[36:39], a[108:111], a[12:15], v[36:39]
ds_read_b64_tr_b16 v[108:109], v9 offset:52288
ds_read_b64_tr_b16 v[110:111], v9 offset:56640
v_add_f32 v10, v10, v50
s_waitcnt lgkmcnt(8)
v_mfma_f32_16x16x32_bf16 v[128:131], v[224:227], v[60:63], v[128:131]
v_exp_f32 v52, v52
v_mfma_f32_16x16x32_bf16 v[132:135], v[228:231], v[60:63], v[132:135]
ds_read_b64_tr_b16 v[112:113], v8 offset:52352
ds_read_b64_tr_b16 v[114:115], v8 offset:56704
v_add_f32 v10, v10, v51
v_cvt_pk_bf16_f32 v65, v50, v51
v_mfma_f32_16x16x32_bf16 v[136:139], v[232:235], v[60:63], v[136:139]
v_exp_f32 v53, v53
v_mfma_f32_16x16x32_bf16 v[140:143], v[236:239], v[60:63], v[140:143]
ds_read_b64_tr_b16 v[116:117], v9 offset:52352
ds_read_b64_tr_b16 v[118:119], v9 offset:56704
v_add_f32 v10, v10, v52
v_mfma_f32_16x16x32_bf16 v[144:147], v[240:243], v[60:63], v[144:147]
v_exp_f32 v54, v54
v_mfma_f32_16x16x32_bf16 v[148:151], v[244:247], v[60:63], v[148:151]
ds_read_b64_tr_b16 v[120:121], v8 offset:52416
ds_read_b64_tr_b16 v[122:123], v8 offset:56768
v_add_f32 v10, v10, v53
v_cvt_pk_bf16_f32 v66, v52, v53
v_mfma_f32_16x16x32_bf16 v[152:155], v[248:251], v[60:63], v[152:155]
v_exp_f32 v55, v55
v_mfma_f32_16x16x32_bf16 v[156:159], v[252:255], v[60:63], v[156:159]
ds_read_b64_tr_b16 v[124:125], v9 offset:52416
ds_read_b64_tr_b16 v[126:127], v9 offset:56768
v_add_f32 v10, v10, v54
v_mfma_f32_16x16x32_bf16 v[40:43], a[48:51], a[16:19], v[20:23]
v_exp_f32 v32, v32
v_mfma_f32_16x16x32_bf16 v[40:43], a[52:55], a[20:23], v[40:43]
ds_read_b64_tr_b16 a[144:145], v8 offset:60928
ds_read_b64_tr_b16 a[146:147], v8 offset:65280
v_add_f32 v10, v10, v55
v_cvt_pk_bf16_f32 v67, v54, v55
v_mfma_f32_16x16x32_bf16 v[40:43], a[56:59], a[24:27], v[40:43]
v_exp_f32 v33, v33
v_mfma_f32_16x16x32_bf16 v[40:43], a[60:63], a[28:31], v[40:43]
ds_read_b64_tr_b16 a[148:149], v9 offset:60928
ds_read_b64_tr_b16 a[150:151], v9 offset:65280
v_add_f32 v10, v10, v32
v_mfma_f32_16x16x32_bf16 v[44:47], a[64:67], a[16:19], v[20:23]
v_exp_f32 v34, v34
v_mfma_f32_16x16x32_bf16 v[44:47], a[68:71], a[20:23], v[44:47]
ds_read_b64_tr_b16 a[152:153], v8 offset:60992
ds_read_b64_tr_b16 a[154:155], v8 offset:65344
v_add_f32 v10, v10, v33
v_cvt_pk_bf16_f32 v56, v32, v33
v_mfma_f32_16x16x32_bf16 v[44:47], a[72:75], a[24:27], v[44:47]
v_exp_f32 v35, v35
v_mfma_f32_16x16x32_bf16 v[44:47], a[76:79], a[28:31], v[44:47]
ds_read_b64_tr_b16 a[156:157], v9 offset:60992
ds_read_b64_tr_b16 a[158:159], v9 offset:65344
v_add_f32 v10, v10, v34
s_waitcnt lgkmcnt(8)
v_mfma_f32_16x16x32_bf16 v[128:131], v[96:99], v[64:67], v[128:131]
v_exp_f32 v36, v36
v_mfma_f32_16x16x32_bf16 v[132:135], v[100:103], v[64:67], v[132:135]
ds_read_b64_tr_b16 a[160:161], v8 offset:61056
ds_read_b64_tr_b16 a[162:163], v8 offset:65408
v_add_f32 v10, v10, v35
v_cvt_pk_bf16_f32 v57, v34, v35
v_mfma_f32_16x16x32_bf16 v[136:139], v[104:107], v[64:67], v[136:139]
v_exp_f32 v37, v37
v_mfma_f32_16x16x32_bf16 v[140:143], v[108:111], v[64:67], v[140:143]
ds_read_b64_tr_b16 a[164:165], v9 offset:61056
ds_read_b64_tr_b16 a[166:167], v9 offset:65408
v_add_f32 v10, v10, v36
v_mfma_f32_16x16x32_bf16 v[144:147], v[112:115], v[64:67], v[144:147]
v_exp_f32 v38, v38
v_mfma_f32_16x16x32_bf16 v[148:151], v[116:119], v[64:67], v[148:151]
ds_read_b64_tr_b16 a[168:169], v8 offset:61120
ds_read_b64_tr_b16 a[170:171], v8 offset:65472
v_add_f32 v10, v10, v37
v_cvt_pk_bf16_f32 v58, v36, v37
v_mfma_f32_16x16x32_bf16 v[152:155], v[120:123], v[64:67], v[152:155]
v_exp_f32 v39, v39
v_mfma_f32_16x16x32_bf16 v[156:159], v[124:127], v[64:67], v[156:159]
ds_read_b64_tr_b16 a[172:173], v9 offset:61120
ds_read_b64_tr_b16 a[174:175], v9 offset:65472
v_add_f32 v10, v10, v38
v_mfma_f32_16x16x32_bf16 v[48:51], a[176:179], a[16:19], v[20:23]
v_exp_f32 v40, v40
v_mfma_f32_16x16x32_bf16 v[48:51], a[180:183], a[20:23], v[48:51]
v_add_f32 v10, v10, v39
v_cvt_pk_bf16_f32 v59, v38, v39
v_mfma_f32_16x16x32_bf16 v[48:51], a[184:187], a[24:27], v[48:51]
v_exp_f32 v41, v41
v_mfma_f32_16x16x32_bf16 v[48:51], a[188:191], a[28:31], v[48:51]
v_add_f32 v11, v11, v40
v_cmp_nlt_f32 s[52:53], v10, s49
v_mfma_f32_16x16x32_bf16 v[52:55], a[192:195], a[16:19], v[20:23]
v_exp_f32 v42, v42
v_mfma_f32_16x16x32_bf16 v[52:55], a[196:199], a[20:23], v[52:55]
v_add_f32 v11, v11, v41
v_cvt_pk_bf16_f32 v60, v40, v41
v_mov_b32 v82, v10
v_mfma_f32_16x16x32_bf16 v[52:55], a[200:203], a[24:27], v[52:55]
v_exp_f32 v43, v43
v_mfma_f32_16x16x32_bf16 v[52:55], a[204:207], a[28:31], v[52:55]
v_add_f32 v11, v11, v42
v_permlane16_swap_b32 v10, v82
s_waitcnt lgkmcnt(0)
v_mfma_f32_16x16x32_bf16 v[128:131], a[144:147], v[56:59], v[128:131]
v_exp_f32 v44, v44
v_mfma_f32_16x16x32_bf16 v[132:135], a[148:151], v[56:59], v[132:135]
v_add_f32 v11, v11, v43
v_cvt_pk_bf16_f32 v61, v42, v43
v_add_f32 v10, v10, v82
v_mfma_f32_16x16x32_bf16 v[136:139], a[152:155], v[56:59], v[136:139]
v_exp_f32 v45, v45
v_mfma_f32_16x16x32_bf16 v[140:143], a[156:159], v[56:59], v[140:143]
v_add_f32 v11, v11, v44
v_mov_b32 v82, v10
v_mfma_f32_16x16x32_bf16 v[144:147], a[160:163], v[56:59], v[144:147]
v_exp_f32 v46, v46
v_mfma_f32_16x16x32_bf16 v[148:151], a[164:167], v[56:59], v[148:151]
v_add_f32 v11, v11, v45
v_cvt_pk_bf16_f32 v62, v44, v45
v_permlane32_swap_b32 v10, v82
v_mfma_f32_16x16x32_bf16 v[152:155], a[168:171], v[56:59], v[152:155]
v_exp_f32 v47, v47
v_mfma_f32_16x16x32_bf16 v[156:159], a[172:175], v[56:59], v[156:159]
v_add_f32 v11, v11, v46
v_add_f32 v10, v10, v82
v_rcp_f32 v80, v10
v_mfma_f32_16x16x32_bf16 v[32:35], a[208:211], a[16:19], v[20:23]
v_exp_f32 v48, v48
v_mfma_f32_16x16x32_bf16 v[32:35], a[212:215], a[20:23], v[32:35]
v_add_f32 v11, v11, v47
v_cvt_pk_bf16_f32 v63, v46, v47
v_pk_mul_f32 v[128:129], v[128:129], v[80:81] op_sel_hi:[1,0]
v_pk_mul_f32 v[130:131], v[130:131], v[80:81] op_sel_hi:[1,0]
v_pk_mul_f32 v[132:133], v[132:133], v[80:81] op_sel_hi:[1,0]
v_pk_mul_f32 v[134:135], v[134:135], v[80:81] op_sel_hi:[1,0]
v_cvt_pk_bf16_f32 v84, v128, v129
v_mfma_f32_16x16x32_bf16 v[32:35], a[216:219], a[24:27], v[32:35]
v_exp_f32 v49, v49
v_mfma_f32_16x16x32_bf16 v[32:35], a[220:223], a[28:31], v[32:35]
v_add_f32 v11, v11, v48
v_cvt_pk_bf16_f32 v85, v130, v131
v_pk_mul_f32 v[136:137], v[136:137], v[80:81] op_sel_hi:[1,0]
v_pk_mul_f32 v[138:139], v[138:139], v[80:81] op_sel_hi:[1,0]
v_cvt_pk_bf16_f32 v86, v132, v133
v_cvt_pk_bf16_f32 v87, v134, v135
v_mfma_f32_16x16x32_bf16 v[36:39], a[224:227], a[16:19], v[20:23]
v_exp_f32 v50, v50
v_mfma_f32_16x16x32_bf16 v[36:39], a[228:231], a[20:23], v[36:39]
v_add_f32 v11, v11, v49
v_cvt_pk_bf16_f32 v64, v48, v49
ds_write_b64 v76, v[84:85] offset:0
v_pk_mul_f32 v[140:141], v[140:141], v[80:81] op_sel_hi:[1,0]
v_pk_mul_f32 v[142:143], v[142:143], v[80:81] op_sel_hi:[1,0]
v_cvt_pk_bf16_f32 v88, v136, v137
v_cvt_pk_bf16_f32 v89, v138, v139
v_mfma_f32_16x16x32_bf16 v[36:39], a[232:235], a[24:27], v[36:39]
v_exp_f32 v51, v51
v_mfma_f32_16x16x32_bf16 v[36:39], a[236:239], a[28:31], v[36:39]
v_add_f32 v11, v11, v50
ds_write_b64 v76, v[86:87] offset:32
v_pk_mul_f32 v[144:145], v[144:145], v[80:81] op_sel_hi:[1,0]
v_pk_mul_f32 v[146:147], v[146:147], v[80:81] op_sel_hi:[1,0]
v_cvt_pk_bf16_f32 v90, v140, v141
v_cvt_pk_bf16_f32 v91, v142, v143
v_mfma_f32_16x16x32_bf16 v[160:163], a[112:115], v[60:63], v[160:163]
v_exp_f32 v52, v52
v_mfma_f32_16x16x32_bf16 v[164:167], a[116:119], v[60:63], v[164:167]
v_add_f32 v11, v11, v51
v_cvt_pk_bf16_f32 v65, v50, v51
ds_write_b64 v76, v[88:89] offset:64
v_pk_mul_f32 v[148:149], v[148:149], v[80:81] op_sel_hi:[1,0]
v_pk_mul_f32 v[150:151], v[150:151], v[80:81] op_sel_hi:[1,0]
v_cvt_pk_bf16_f32 v84, v144, v145
v_cvt_pk_bf16_f32 v85, v146, v147
v_mfma_f32_16x16x32_bf16 v[168:171], a[120:123], v[60:63], v[168:171]
v_exp_f32 v53, v53
v_mfma_f32_16x16x32_bf16 v[172:175], a[124:127], v[60:63], v[172:175]
v_add_f32 v11, v11, v52
ds_write_b64 v76, v[90:91] offset:96
v_pk_mul_f32 v[152:153], v[152:153], v[80:81] op_sel_hi:[1,0]
v_pk_mul_f32 v[154:155], v[154:155], v[80:81] op_sel_hi:[1,0]
v_cvt_pk_bf16_f32 v86, v148, v149
v_cvt_pk_bf16_f32 v87, v150, v151
v_mfma_f32_16x16x32_bf16 v[176:179], a[128:131], v[60:63], v[176:179]
v_exp_f32 v54, v54
v_mfma_f32_16x16x32_bf16 v[180:183], a[132:135], v[60:63], v[180:183]
v_add_f32 v11, v11, v53
v_cvt_pk_bf16_f32 v66, v52, v53
ds_write_b64 v76, v[84:85] offset:128
v_pk_mul_f32 v[156:157], v[156:157], v[80:81] op_sel_hi:[1,0]
v_pk_mul_f32 v[158:159], v[158:159], v[80:81] op_sel_hi:[1,0]
v_cvt_pk_bf16_f32 v88, v152, v153
v_cvt_pk_bf16_f32 v89, v154, v155
v_mfma_f32_16x16x32_bf16 v[184:187], a[136:139], v[60:63], v[184:187]
v_exp_f32 v55, v55
v_mfma_f32_16x16x32_bf16 v[188:191], a[140:143], v[60:63], v[188:191]
v_add_f32 v11, v11, v54
ds_write_b64 v76, v[86:87] offset:160
v_cvt_pk_bf16_f32 v90, v156, v157
v_cvt_pk_bf16_f32 v91, v158, v159
ds_write_b64 v76, v[88:89] offset:192
ds_write_b64 v76, v[90:91] offset:224
v_mfma_f32_16x16x32_bf16 v[40:43], a[80:83], a[16:19], v[20:23]
v_exp_f32 v32, v32
v_mfma_f32_16x16x32_bf16 v[40:43], a[84:87], a[20:23], v[40:43]
v_add_f32 v11, v11, v55
v_cvt_pk_bf16_f32 v67, v54, v55
s_waitcnt lgkmcnt(0)
ds_read_b128 v[128:131], v77 offset:0
ds_read_b128 v[132:135], v77 offset:1088
v_mfma_f32_16x16x32_bf16 v[40:43], a[88:91], a[24:27], v[40:43]
v_exp_f32 v33, v33
v_mfma_f32_16x16x32_bf16 v[40:43], a[92:95], a[28:31], v[40:43]
v_add_f32 v11, v11, v32
ds_read_b128 v[136:139], v77 offset:2176
ds_read_b128 v[140:143], v77 offset:3264
s_add_u32 s47, s36, 0
v_mfma_f32_16x16x32_bf16 v[44:47], a[96:99], a[16:19], v[20:23]
v_exp_f32 v34, v34
v_mfma_f32_16x16x32_bf16 v[44:47], a[100:103], a[20:23], v[44:47]
v_add_f32 v11, v11, v33
v_cvt_pk_bf16_f32 v56, v32, v33
v_mfma_f32_16x16x32_bf16 v[44:47], a[104:107], a[24:27], v[44:47]
v_exp_f32 v35, v35
v_mfma_f32_16x16x32_bf16 v[44:47], a[108:111], a[28:31], v[44:47]
v_add_f32 v11, v11, v34
s_waitcnt lgkmcnt(0)
buffer_store_dwordx4 v[128:131], v78, s[32:35], s47 offen offset:0 nt
buffer_store_dwordx4 v[132:135], v78, s[32:35], s47 offen offset:1024 nt
v_mfma_f32_16x16x32_bf16 v[160:163], v[224:227], v[64:67], v[160:163]
v_exp_f32 v36, v36
v_mfma_f32_16x16x32_bf16 v[164:167], v[228:231], v[64:67], v[164:167]
v_add_f32 v11, v11, v35
v_cvt_pk_bf16_f32 v57, v34, v35
buffer_store_dwordx4 v[136:139], v78, s[32:35], s47 offen offset:2048 nt
buffer_store_dwordx4 v[140:143], v78, s[32:35], s47 offen offset:3072 nt
v_mfma_f32_16x16x32_bf16 v[168:171], v[232:235], v[64:67], v[168:171]
v_exp_f32 v37, v37
v_mfma_f32_16x16x32_bf16 v[172:175], v[236:239], v[64:67], v[172:175]
v_add_f32 v11, v11, v36
v_mfma_f32_16x16x32_bf16 v[176:179], v[240:243], v[64:67], v[176:179]
v_exp_f32 v38, v38
v_mfma_f32_16x16x32_bf16 v[180:183], v[244:247], v[64:67], v[180:183]
v_add_f32 v11, v11, v37
v_cvt_pk_bf16_f32 v58, v36, v37
v_mfma_f32_16x16x32_bf16 v[184:187], v[248:251], v[64:67], v[184:187]
v_exp_f32 v39, v39
v_mfma_f32_16x16x32_bf16 v[188:191], v[252:255], v[64:67], v[188:191]
v_add_f32 v11, v11, v38
v_mfma_f32_16x16x32_bf16 v[48:51], a[48:51], a[32:35], v[24:27]
v_exp_f32 v40, v40
v_mfma_f32_16x16x32_bf16 v[48:51], a[52:55], a[36:39], v[48:51]
v_add_f32 v11, v11, v39
v_cvt_pk_bf16_f32 v59, v38, v39
v_mfma_f32_16x16x32_bf16 v[48:51], a[56:59], a[40:43], v[48:51]
v_exp_f32 v41, v41
v_mfma_f32_16x16x32_bf16 v[48:51], a[60:63], a[44:47], v[48:51]
v_add_f32 v11, v11, v40
v_mfma_f32_16x16x32_bf16 v[52:55], a[64:67], a[32:35], v[24:27]
v_exp_f32 v42, v42
v_mfma_f32_16x16x32_bf16 v[52:55], a[68:71], a[36:39], v[52:55]
v_add_f32 v11, v11, v41
v_cvt_pk_bf16_f32 v60, v40, v41
v_mfma_f32_16x16x32_bf16 v[52:55], a[72:75], a[40:43], v[52:55]
v_exp_f32 v43, v43
v_mfma_f32_16x16x32_bf16 v[52:55], a[76:79], a[44:47], v[52:55]
v_add_f32 v11, v11, v42
v_mfma_f32_16x16x32_bf16 v[160:163], v[96:99], v[56:59], v[160:163]
v_exp_f32 v44, v44
v_mfma_f32_16x16x32_bf16 v[164:167], v[100:103], v[56:59], v[164:167]
v_add_f32 v11, v11, v43
v_cvt_pk_bf16_f32 v61, v42, v43
v_mfma_f32_16x16x32_bf16 v[168:171], v[104:107], v[56:59], v[168:171]
v_exp_f32 v45, v45
v_mfma_f32_16x16x32_bf16 v[172:175], v[108:111], v[56:59], v[172:175]
v_add_f32 v11, v11, v44
v_mfma_f32_16x16x32_bf16 v[176:179], v[112:115], v[56:59], v[176:179]
v_exp_f32 v46, v46
v_mfma_f32_16x16x32_bf16 v[180:183], v[116:119], v[56:59], v[180:183]
v_add_f32 v11, v11, v45
v_cvt_pk_bf16_f32 v62, v44, v45
v_mfma_f32_16x16x32_bf16 v[184:187], v[120:123], v[56:59], v[184:187]
v_exp_f32 v47, v47
v_mfma_f32_16x16x32_bf16 v[188:191], v[124:127], v[56:59], v[188:191]
v_add_f32 v11, v11, v46
v_mfma_f32_16x16x32_bf16 v[32:35], a[176:179], a[32:35], v[24:27]
v_exp_f32 v48, v48
v_mfma_f32_16x16x32_bf16 v[32:35], a[180:183], a[36:39], v[32:35]
v_add_f32 v11, v11, v47
v_cvt_pk_bf16_f32 v63, v46, v47
v_mfma_f32_16x16x32_bf16 v[32:35], a[184:187], a[40:43], v[32:35]
v_exp_f32 v49, v49
v_mfma_f32_16x16x32_bf16 v[32:35], a[188:191], a[44:47], v[32:35]
v_add_f32 v12, v12, v48
v_cmp_nlt_f32 s[56:57], v11, s49
v_mfma_f32_16x16x32_bf16 v[36:39], a[192:195], a[32:35], v[24:27]
v_exp_f32 v50, v50
v_mfma_f32_16x16x32_bf16 v[36:39], a[196:199], a[36:39], v[36:39]
v_add_f32 v12, v12, v49
v_cvt_pk_bf16_f32 v64, v48, v49
v_mov_b32 v82, v11
v_mfma_f32_16x16x32_bf16 v[36:39], a[200:203], a[40:43], v[36:39]
v_exp_f32 v51, v51
v_mfma_f32_16x16x32_bf16 v[36:39], a[204:207], a[44:47], v[36:39]
v_add_f32 v12, v12, v50
v_permlane16_swap_b32 v11, v82
v_mfma_f32_16x16x32_bf16 v[160:163], a[144:147], v[60:63], v[160:163]
v_exp_f32 v52, v52
v_mfma_f32_16x16x32_bf16 v[164:167], a[148:151], v[60:63], v[164:167]
v_add_f32 v12, v12, v51
v_cvt_pk_bf16_f32 v65, v50, v51
v_add_f32 v11, v11, v82
v_mfma_f32_16x16x32_bf16 v[168:171], a[152:155], v[60:63], v[168:171]
v_exp_f32 v53, v53
v_mfma_f32_16x16x32_bf16 v[172:175], a[156:159], v[60:63], v[172:175]
v_add_f32 v12, v12, v52
v_mov_b32 v82, v11
v_mfma_f32_16x16x32_bf16 v[176:179], a[160:163], v[60:63], v[176:179]
v_exp_f32 v54, v54
v_mfma_f32_16x16x32_bf16 v[180:183], a[164:167], v[60:63], v[180:183]
v_add_f32 v12, v12, v53
v_cvt_pk_bf16_f32 v66, v52, v53
v_permlane32_swap_b32 v11, v82
v_mfma_f32_16x16x32_bf16 v[184:187], a[168:171], v[60:63], v[184:187]
v_exp_f32 v55, v55
v_mfma_f32_16x16x32_bf16 v[188:191], a[172:175], v[60:63], v[188:191]
v_add_f32 v12, v12, v54
v_add_f32 v11, v11, v82
v_rcp_f32 v80, v11
v_mfma_f32_16x16x32_bf16 v[40:43], a[208:211], a[32:35], v[24:27]
v_exp_f32 v32, v32
v_mfma_f32_16x16x32_bf16 v[40:43], a[212:215], a[36:39], v[40:43]
v_add_f32 v12, v12, v55
v_cvt_pk_bf16_f32 v67, v54, v55
v_pk_mul_f32 v[160:161], v[160:161], v[80:81] op_sel_hi:[1,0]
v_pk_mul_f32 v[162:163], v[162:163], v[80:81] op_sel_hi:[1,0]
v_pk_mul_f32 v[164:165], v[164:165], v[80:81] op_sel_hi:[1,0]
v_pk_mul_f32 v[166:167], v[166:167], v[80:81] op_sel_hi:[1,0]
v_cvt_pk_bf16_f32 v84, v160, v161
v_mfma_f32_16x16x32_bf16 v[40:43], a[216:219], a[40:43], v[40:43]
v_exp_f32 v33, v33
v_mfma_f32_16x16x32_bf16 v[40:43], a[220:223], a[44:47], v[40:43]
v_add_f32 v12, v12, v32
v_cvt_pk_bf16_f32 v85, v162, v163
v_pk_mul_f32 v[168:169], v[168:169], v[80:81] op_sel_hi:[1,0]
v_pk_mul_f32 v[170:171], v[170:171], v[80:81] op_sel_hi:[1,0]
v_cvt_pk_bf16_f32 v86, v164, v165
v_cvt_pk_bf16_f32 v87, v166, v167
v_mfma_f32_16x16x32_bf16 v[44:47], a[224:227], a[32:35], v[24:27]
v_exp_f32 v34, v34
v_mfma_f32_16x16x32_bf16 v[44:47], a[228:231], a[36:39], v[44:47]
v_add_f32 v12, v12, v33
v_cvt_pk_bf16_f32 v56, v32, v33
ds_write_b64 v76, v[84:85] offset:4352
v_pk_mul_f32 v[172:173], v[172:173], v[80:81] op_sel_hi:[1,0]
v_pk_mul_f32 v[174:175], v[174:175], v[80:81] op_sel_hi:[1,0]
v_cvt_pk_bf16_f32 v88, v168, v169
v_cvt_pk_bf16_f32 v89, v170, v171
v_mfma_f32_16x16x32_bf16 v[44:47], a[232:235], a[40:43], v[44:47]
v_exp_f32 v35, v35
v_mfma_f32_16x16x32_bf16 v[44:47], a[236:239], a[44:47], v[44:47]
v_add_f32 v12, v12, v34
ds_write_b64 v76, v[86:87] offset:4384
v_pk_mul_f32 v[176:177], v[176:177], v[80:81] op_sel_hi:[1,0]
v_pk_mul_f32 v[178:179], v[178:179], v[80:81] op_sel_hi:[1,0]
v_cvt_pk_bf16_f32 v90, v172, v173
v_cvt_pk_bf16_f32 v91, v174, v175
v_mfma_f32_16x16x32_bf16 v[192:195], a[112:115], v[64:67], v[192:195]
v_exp_f32 v36, v36
v_mfma_f32_16x16x32_bf16 v[196:199], a[116:119], v[64:67], v[196:199]
v_add_f32 v12, v12, v35
v_cvt_pk_bf16_f32 v57, v34, v35
ds_write_b64 v76, v[88:89] offset:4416
v_pk_mul_f32 v[180:181], v[180:181], v[80:81] op_sel_hi:[1,0]
v_pk_mul_f32 v[182:183], v[182:183], v[80:81] op_sel_hi:[1,0]
v_cvt_pk_bf16_f32 v84, v176, v177
v_cvt_pk_bf16_f32 v85, v178, v179
v_mfma_f32_16x16x32_bf16 v[200:203], a[120:123], v[64:67], v[200:203]
v_exp_f32 v37, v37
v_mfma_f32_16x16x32_bf16 v[204:207], a[124:127], v[64:67], v[204:207]
v_add_f32 v12, v12, v36
ds_write_b64 v76, v[90:91] offset:4448
v_pk_mul_f32 v[184:185], v[184:185], v[80:81] op_sel_hi:[1,0]
v_pk_mul_f32 v[186:187], v[186:187], v[80:81] op_sel_hi:[1,0]
v_cvt_pk_bf16_f32 v86, v180, v181
v_cvt_pk_bf16_f32 v87, v182, v183
v_mfma_f32_16x16x32_bf16 v[208:211], a[128:131], v[64:67], v[208:211]
v_exp_f32 v38, v38
v_mfma_f32_16x16x32_bf16 v[212:215], a[132:135], v[64:67], v[212:215]
v_add_f32 v12, v12, v37
v_cvt_pk_bf16_f32 v58, v36, v37
ds_write_b64 v76, v[84:85] offset:4480
v_pk_mul_f32 v[188:189], v[188:189], v[80:81] op_sel_hi:[1,0]
v_pk_mul_f32 v[190:191], v[190:191], v[80:81] op_sel_hi:[1,0]
v_cvt_pk_bf16_f32 v88, v184, v185
v_cvt_pk_bf16_f32 v89, v186, v187
v_mfma_f32_16x16x32_bf16 v[216:219], a[136:139], v[64:67], v[216:219]
v_exp_f32 v39, v39
v_mfma_f32_16x16x32_bf16 v[220:223], a[140:143], v[64:67], v[220:223]
v_add_f32 v12, v12, v38
ds_write_b64 v76, v[86:87] offset:4512
v_cvt_pk_bf16_f32 v90, v188, v189
v_cvt_pk_bf16_f32 v91, v190, v191
ds_write_b64 v76, v[88:89] offset:4544
ds_write_b64 v76, v[90:91] offset:4576
v_mfma_f32_16x16x32_bf16 v[48:51], a[80:83], a[32:35], v[24:27]
v_exp_f32 v40, v40
v_mfma_f32_16x16x32_bf16 v[48:51], a[84:87], a[36:39], v[48:51]
v_add_f32 v12, v12, v39
v_cvt_pk_bf16_f32 v59, v38, v39
s_waitcnt lgkmcnt(0)
ds_read_b128 v[160:163], v77 offset:4352
ds_read_b128 v[164:167], v77 offset:5440
v_mfma_f32_16x16x32_bf16 v[48:51], a[88:91], a[40:43], v[48:51]
v_exp_f32 v41, v41
v_mfma_f32_16x16x32_bf16 v[48:51], a[92:95], a[44:47], v[48:51]
v_add_f32 v12, v12, v40
ds_read_b128 v[168:171], v77 offset:6528
ds_read_b128 v[172:175], v77 offset:7616
s_add_u32 s47, s36, 4096
v_mfma_f32_16x16x32_bf16 v[52:55], a[96:99], a[32:35], v[24:27]
v_exp_f32 v42, v42
v_mfma_f32_16x16x32_bf16 v[52:55], a[100:103], a[36:39], v[52:55]
v_add_f32 v12, v12, v41
v_cvt_pk_bf16_f32 v60, v40, v41
v_mfma_f32_16x16x32_bf16 v[52:55], a[104:107], a[40:43], v[52:55]
v_exp_f32 v43, v43
v_mfma_f32_16x16x32_bf16 v[52:55], a[108:111], a[44:47], v[52:55]
v_add_f32 v12, v12, v42
s_waitcnt lgkmcnt(0)
buffer_store_dwordx4 v[160:163], v78, s[32:35], s47 offen offset:0 nt
buffer_store_dwordx4 v[164:167], v78, s[32:35], s47 offen offset:1024 nt
v_mfma_f32_16x16x32_bf16 v[192:195], v[224:227], v[56:59], v[192:195]
v_exp_f32 v44, v44
v_mfma_f32_16x16x32_bf16 v[196:199], v[228:231], v[56:59], v[196:199]
v_add_f32 v12, v12, v43
v_cvt_pk_bf16_f32 v61, v42, v43
buffer_store_dwordx4 v[168:171], v78, s[32:35], s47 offen offset:2048 nt
buffer_store_dwordx4 v[172:175], v78, s[32:35], s47 offen offset:3072 nt
v_mfma_f32_16x16x32_bf16 v[200:203], v[232:235], v[56:59], v[200:203]
v_exp_f32 v45, v45
v_mfma_f32_16x16x32_bf16 v[204:207], v[236:239], v[56:59], v[204:207]
v_add_f32 v12, v12, v44
v_mfma_f32_16x16x32_bf16 v[208:211], v[240:243], v[56:59], v[208:211]
v_exp_f32 v46, v46
v_mfma_f32_16x16x32_bf16 v[212:215], v[244:247], v[56:59], v[212:215]
v_add_f32 v12, v12, v45
v_cvt_pk_bf16_f32 v62, v44, v45
v_mfma_f32_16x16x32_bf16 v[216:219], v[248:251], v[56:59], v[216:219]
v_exp_f32 v47, v47
v_mfma_f32_16x16x32_bf16 v[220:223], v[252:255], v[56:59], v[220:223]
v_add_f32 v12, v12, v46
v_add_f32 v12, v12, v47
v_cvt_pk_bf16_f32 v63, v46, v47
v_exp_f32 v48, v48
v_exp_f32 v49, v49
v_mfma_f32_16x16x32_bf16 v[192:195], v[96:99], v[60:63], v[192:195]
v_add_f32 v12, v12, v48
v_exp_f32 v50, v50
v_add_f32 v12, v12, v49
v_mfma_f32_16x16x32_bf16 v[196:199], v[100:103], v[60:63], v[196:199]
v_cvt_pk_bf16_f32 v64, v48, v49
v_exp_f32 v51, v51
v_add_f32 v12, v12, v50
v_mfma_f32_16x16x32_bf16 v[200:203], v[104:107], v[60:63], v[200:203]
v_exp_f32 v52, v52
v_add_f32 v12, v12, v51
v_cvt_pk_bf16_f32 v65, v50, v51
v_mfma_f32_16x16x32_bf16 v[204:207], v[108:111], v[60:63], v[204:207]
v_exp_f32 v53, v53
v_add_f32 v12, v12, v52
v_exp_f32 v54, v54
v_mfma_f32_16x16x32_bf16 v[208:211], v[112:115], v[60:63], v[208:211]
v_add_f32 v12, v12, v53
v_cvt_pk_bf16_f32 v66, v52, v53
v_mfma_f32_16x16x32_bf16 v[212:215], v[116:119], v[60:63], v[212:215]
v_exp_f32 v55, v55
v_add_f32 v12, v12, v54
v_mfma_f32_16x16x32_bf16 v[216:219], v[120:123], v[60:63], v[216:219]
v_add_f32 v12, v12, v55
v_cvt_pk_bf16_f32 v67, v54, v55
v_mfma_f32_16x16x32_bf16 v[220:223], v[124:127], v[60:63], v[220:223]
s_nop 1
v_mfma_f32_16x16x32_bf16 v[192:195], a[144:147], v[64:67], v[192:195]
v_cmp_nlt_f32 s[58:59], v12, s49
v_mov_b32 v82, v12
v_mfma_f32_16x16x32_bf16 v[196:199], a[148:151], v[64:67], v[196:199]
v_mfma_f32_16x16x32_bf16 v[200:203], a[152:155], v[64:67], v[200:203]
v_permlane16_swap_b32 v12, v82
v_mfma_f32_16x16x32_bf16 v[204:207], a[156:159], v[64:67], v[204:207]
v_add_f32 v12, v12, v82
v_mfma_f32_16x16x32_bf16 v[208:211], a[160:163], v[64:67], v[208:211]
v_mov_b32 v82, v12
v_mfma_f32_16x16x32_bf16 v[212:215], a[164:167], v[64:67], v[212:215]
v_mfma_f32_16x16x32_bf16 v[216:219], a[168:171], v[64:67], v[216:219]
v_permlane32_swap_b32 v12, v82
v_mfma_f32_16x16x32_bf16 v[220:223], a[172:175], v[64:67], v[220:223]
v_add_f32 v12, v12, v82
s_nop 0
v_rcp_f32 v80, v12
s_nop 3
v_pk_mul_f32 v[192:193], v[192:193], v[80:81] op_sel_hi:[1,0]
v_pk_mul_f32 v[194:195], v[194:195], v[80:81] op_sel_hi:[1,0]
v_pk_mul_f32 v[196:197], v[196:197], v[80:81] op_sel_hi:[1,0]
v_pk_mul_f32 v[198:199], v[198:199], v[80:81] op_sel_hi:[1,0]
v_cvt_pk_bf16_f32 v84, v192, v193
v_cvt_pk_bf16_f32 v85, v194, v195
v_pk_mul_f32 v[200:201], v[200:201], v[80:81] op_sel_hi:[1,0]
v_pk_mul_f32 v[202:203], v[202:203], v[80:81] op_sel_hi:[1,0]
v_cvt_pk_bf16_f32 v86, v196, v197
v_cvt_pk_bf16_f32 v87, v198, v199
ds_write_b64 v76, v[84:85] offset:8704
v_pk_mul_f32 v[204:205], v[204:205], v[80:81] op_sel_hi:[1,0]
v_pk_mul_f32 v[206:207], v[206:207], v[80:81] op_sel_hi:[1,0]
v_cvt_pk_bf16_f32 v88, v200, v201
v_cvt_pk_bf16_f32 v89, v202, v203
ds_write_b64 v76, v[86:87] offset:8736
v_pk_mul_f32 v[208:209], v[208:209], v[80:81] op_sel_hi:[1,0]
v_pk_mul_f32 v[210:211], v[210:211], v[80:81] op_sel_hi:[1,0]
v_cvt_pk_bf16_f32 v90, v204, v205
v_cvt_pk_bf16_f32 v91, v206, v207
ds_write_b64 v76, v[88:89] offset:8768
v_pk_mul_f32 v[212:213], v[212:213], v[80:81] op_sel_hi:[1,0]
v_pk_mul_f32 v[214:215], v[214:215], v[80:81] op_sel_hi:[1,0]
v_cvt_pk_bf16_f32 v84, v208, v209
v_cvt_pk_bf16_f32 v85, v210, v211
ds_write_b64 v76, v[90:91] offset:8800
v_pk_mul_f32 v[216:217], v[216:217], v[80:81] op_sel_hi:[1,0]
v_pk_mul_f32 v[218:219], v[218:219], v[80:81] op_sel_hi:[1,0]
v_cvt_pk_bf16_f32 v86, v212, v213
v_cvt_pk_bf16_f32 v87, v214, v215
ds_write_b64 v76, v[84:85] offset:8832
v_pk_mul_f32 v[220:221], v[220:221], v[80:81] op_sel_hi:[1,0]
v_pk_mul_f32 v[222:223], v[222:223], v[80:81] op_sel_hi:[1,0]
v_cvt_pk_bf16_f32 v88, v216, v217
v_cvt_pk_bf16_f32 v89, v218, v219
ds_write_b64 v76, v[86:87] offset:8864
v_cvt_pk_bf16_f32 v90, v220, v221
v_cvt_pk_bf16_f32 v91, v222, v223
ds_write_b64 v76, v[88:89] offset:8896
ds_write_b64 v76, v[90:91] offset:8928
s_or_b64 s[52:53], s[52:53], s[56:57]
s_or_b64 s[52:53], s[52:53], s[58:59]
s_cmp_lg_u64 s[52:53], 0
s_cselect_b32 s45, 1, 0
s_lshl_b32 s46, s16, 2
v_mov_b32 v28, s46
v_mov_b32 v29, s45
s_add_u32 s47, s36, 8192
s_waitcnt lgkmcnt(0)
ds_read_b128 v[192:195], v77 offset:8704
ds_read_b128 v[196:199], v77 offset:9792
ds_read_b128 v[200:203], v77 offset:10880
ds_read_b128 v[204:207], v77 offset:11968
ds_write_b32 v28, v29 offset:52224
s_waitcnt lgkmcnt(4)
buffer_store_dwordx4 v[192:195], v78, s[32:35], s47 offen offset:0 nt
s_waitcnt lgkmcnt(3)
buffer_store_dwordx4 v[196:199], v78, s[32:35], s47 offen offset:1024 nt
s_waitcnt lgkmcnt(2)
buffer_store_dwordx4 v[200:203], v78, s[32:35], s47 offen offset:2048 nt
s_waitcnt lgkmcnt(1)
buffer_store_dwordx4 v[204:207], v78, s[32:35], s47 offen offset:3072 nt
s_waitcnt lgkmcnt(0)
s_barrier
v_mov_b32 v28, 0
ds_read_b128 v[84:87], v28 offset:52224
s_waitcnt lgkmcnt(0)
v_or3_b32 v84, v84, v85, v86
v_or_b32 v84, v84, v87
s_nop 0
v_readfirstlane_b32 s45, v84
s_xor_b32 s46, s44, 1
s_nop 2
s_and_b32 s45, s45, s46
s_cmp_lg_u32 s45, 0
s_cbranch_scc1 L_redo
L_fin:
s_endpgm
L_redo:
s_waitcnt vmcnt(0) lgkmcnt(0)
s_barrier
s_mov_b32 s50, 0
v_mov_b32 v7, v4
v_mov_b32 v8, v5
v_mov_b32 v9, v6
L_mx:
s_mov_b32 m0, s38
s_add_u32 s54, s37, s50
buffer_load_dwordx4 v68, s[24:27], s54 offen offset:0 lds
buffer_load_dwordx4 v69, s[24:27], s54 offen offset:1088 lds
buffer_load_dwordx4 v70, s[24:27], s54 offen offset:2176 lds
buffer_load_dwordx4 v71, s[24:27], s54 offen offset:3264 lds
s_waitcnt vmcnt(0)
s_barrier
ds_read_b128 a[48:51], v7 offset:0
ds_read_b128 a[52:55], v7 offset:64
ds_read_b128 a[56:59], v7 offset:128
ds_read_b128 a[60:63], v7 offset:192
ds_read_b128 a[64:67], v7 offset:4352
ds_read_b128 a[68:71], v7 offset:4416
ds_read_b128 a[72:75], v7 offset:4480
ds_read_b128 a[76:79], v7 offset:4544
ds_read_b128 a[80:83], v7 offset:8704
ds_read_b128 a[84:87], v7 offset:8768
ds_read_b128 a[88:91], v7 offset:8832
ds_read_b128 a[92:95], v7 offset:8896
ds_read_b128 a[96:99], v7 offset:13056
ds_read_b128 a[100:103], v7 offset:13120
ds_read_b128 a[104:107], v7 offset:13184
ds_read_b128 a[108:111], v7 offset:13248
s_waitcnt lgkmcnt(0)
v_mfma_f32_16x16x32_bf16 v[32:35], a[48:51], a[0:3], 0
v_mfma_f32_16x16x32_bf16 v[32:35], a[52:55], a[4:7], v[32:35]
v_mfma_f32_16x16x32_bf16 v[32:35], a[56:59], a[8:11], v[32:35]
v_mfma_f32_16x16x32_bf16 v[32:35], a[60:63], a[12:15], v[32:35]
v_mfma_f32_16x16x32_bf16 v[36:39], a[64:67], a[0:3], 0
v_mfma_f32_16x16x32_bf16 v[36:39], a[68:71], a[4:7], v[36:39]
v_mfma_f32_16x16x32_bf16 v[36:39], a[72:75], a[8:11], v[36:39]
v_mfma_f32_16x16x32_bf16 v[36:39], a[76:79], a[12:15], v[36:39]
v_mfma_f32_16x16x32_bf16 v[40:43], a[48:51], a[16:19], 0
v_mfma_f32_16x16x32_bf16 v[40:43], a[52:55], a[20:23], v[40:43]
v_mfma_f32_16x16x32_bf16 v[40:43], a[56:59], a[24:27], v[40:43]
v_mfma_f32_16x16x32_bf16 v[40:43], a[60:63], a[28:31], v[40:43]
v_mfma_f32_16x16x32_bf16 v[44:47], a[64:67], a[16:19], 0
v_mfma_f32_16x16x32_bf16 v[44:47], a[68:71], a[20:23], v[44:47]
v_mfma_f32_16x16x32_bf16 v[44:47], a[72:75], a[24:27], v[44:47]
v_mfma_f32_16x16x32_bf16 v[44:47], a[76:79], a[28:31], v[44:47]
v_mfma_f32_16x16x32_bf16 v[48:51], a[48:51], a[32:35], 0
v_mfma_f32_16x16x32_bf16 v[48:51], a[52:55], a[36:39], v[48:51]
v_mfma_f32_16x16x32_bf16 v[48:51], a[56:59], a[40:43], v[48:51]
v_mfma_f32_16x16x32_bf16 v[48:51], a[60:63], a[44:47], v[48:51]
v_mfma_f32_16x16x32_bf16 v[52:55], a[64:67], a[32:35], 0
v_mfma_f32_16x16x32_bf16 v[52:55], a[68:71], a[36:39], v[52:55]
v_mfma_f32_16x16x32_bf16 v[52:55], a[72:75], a[40:43], v[52:55]
v_mfma_f32_16x16x32_bf16 v[52:55], a[76:79], a[44:47], v[52:55]
s_nop 15
v_max3_f32 v13, v32, v33, v13
v_max3_f32 v13, v34, v35, v13
v_max3_f32 v13, v36, v37, v13
v_max3_f32 v13, v38, v39, v13
v_max3_f32 v14, v40, v41, v14
v_max3_f32 v14, v42, v43, v14
v_max3_f32 v14, v44, v45, v14
v_max3_f32 v14, v46, v47, v14
v_max3_f32 v15, v48, v49, v15
v_max3_f32 v15, v50, v51, v15
v_max3_f32 v15, v52, v53, v15
v_max3_f32 v15, v54, v55, v15
s_nop 7
v_mfma_f32_16x16x32_bf16 v[32:35], a[80:83], a[0:3], 0
v_mfma_f32_16x16x32_bf16 v[32:35], a[84:87], a[4:7], v[32:35]
v_mfma_f32_16x16x32_bf16 v[32:35], a[88:91], a[8:11], v[32:35]
v_mfma_f32_16x16x32_bf16 v[32:35], a[92:95], a[12:15], v[32:35]
v_mfma_f32_16x16x32_bf16 v[36:39], a[96:99], a[0:3], 0
v_mfma_f32_16x16x32_bf16 v[36:39], a[100:103], a[4:7], v[36:39]
v_mfma_f32_16x16x32_bf16 v[36:39], a[104:107], a[8:11], v[36:39]
v_mfma_f32_16x16x32_bf16 v[36:39], a[108:111], a[12:15], v[36:39]
v_mfma_f32_16x16x32_bf16 v[40:43], a[80:83], a[16:19], 0
v_mfma_f32_16x16x32_bf16 v[40:43], a[84:87], a[20:23], v[40:43]
v_mfma_f32_16x16x32_bf16 v[40:43], a[88:91], a[24:27], v[40:43]
v_mfma_f32_16x16x32_bf16 v[40:43], a[92:95], a[28:31], v[40:43]
v_mfma_f32_16x16x32_bf16 v[44:47], a[96:99], a[16:19], 0
v_mfma_f32_16x16x32_bf16 v[44:47], a[100:103], a[20:23], v[44:47]
v_mfma_f32_16x16x32_bf16 v[44:47], a[104:107], a[24:27], v[44:47]
v_mfma_f32_16x16x32_bf16 v[44:47], a[108:111], a[28:31], v[44:47]
v_mfma_f32_16x16x32_bf16 v[48:51], a[80:83], a[32:35], 0
v_mfma_f32_16x16x32_bf16 v[48:51], a[84:87], a[36:39], v[48:51]
v_mfma_f32_16x16x32_bf16 v[48:51], a[88:91], a[40:43], v[48:51]
v_mfma_f32_16x16x32_bf16 v[48:51], a[92:95], a[44:47], v[48:51]
v_mfma_f32_16x16x32_bf16 v[52:55], a[96:99], a[32:35], 0
v_mfma_f32_16x16x32_bf16 v[52:55], a[100:103], a[36:39], v[52:55]
v_mfma_f32_16x16x32_bf16 v[52:55], a[104:107], a[40:43], v[52:55]
v_mfma_f32_16x16x32_bf16 v[52:55], a[108:111], a[44:47], v[52:55]
s_nop 15
v_max3_f32 v13, v32, v33, v13
v_max3_f32 v13, v34, v35, v13
v_max3_f32 v13, v36, v37, v13
v_max3_f32 v13, v38, v39, v13
v_max3_f32 v14, v40, v41, v14
v_max3_f32 v14, v42, v43, v14
v_max3_f32 v14, v44, v45, v14
v_max3_f32 v14, v46, v47, v14
v_max3_f32 v15, v48, v49, v15
v_max3_f32 v15, v50, v51, v15
v_max3_f32 v15, v52, v53, v15
v_max3_f32 v15, v54, v55, v15
s_nop 7
s_barrier
s_add_u32 s50, s50, 16384
s_cmp_lt_u32 s50, 131072
s_cbranch_scc1 L_mx
v_mov_b32 v28, v13
s_nop 1
v_permlane16_swap_b32 v13, v28
s_nop 1
v_max_f32 v13, v13, v28
s_nop 1
v_mov_b32 v28, v13
s_nop 1
v_permlane32_swap_b32 v13, v28
s_nop 1
v_max_f32 v13, v13, v28
s_nop 1
v_mov_b32 v28, v14
s_nop 1
v_permlane16_swap_b32 v14, v28
s_nop 1
v_max_f32 v14, v14, v28
s_nop 1
v_mov_b32 v28, v14
s_nop 1
v_permlane32_swap_b32 v14, v28
s_nop 1
v_max_f32 v14, v14, v28
s_nop 1
v_mov_b32 v28, v15
s_nop 1
v_permlane16_swap_b32 v15, v28
s_nop 1
v_max_f32 v15, v15, v28
s_nop 1
v_mov_b32 v28, v15
s_nop 1
v_permlane32_swap_b32 v15, v28
s_nop 1
v_max_f32 v15, v15, v28
s_nop 1
s_mov_b32 s44, 1
s_add_u32 m0, s38, 0
s_add_u32 s54, s37, 0
buffer_load_dwordx4 v68, s[24:27], s54 offen offset:0 sc1 nt lds
buffer_load_dwordx4 v69, s[24:27], s54 offen offset:1088 sc1 nt lds
buffer_load_dwordx4 v70, s[24:27], s54 offen offset:2176 sc1 nt lds
buffer_load_dwordx4 v71, s[24:27], s54 offen offset:3264 sc1 nt lds
s_add_u32 m0, s38, 17408
s_add_u32 s54, s37, 0
buffer_load_dwordx4 v72, s[28:31], s54 offen offset:0 sc1 nt lds
buffer_load_dwordx4 v73, s[28:31], s54 offen offset:1088 sc1 nt lds
buffer_load_dwordx4 v74, s[28:31], s54 offen offset:2176 sc1 nt lds
buffer_load_dwordx4 v75, s[28:31], s54 offen offset:3264 sc1 nt lds
s_add_u32 m0, s38, 34816
s_add_u32 s54, s37, 16384
buffer_load_dwordx4 v68, s[24:27], s54 offen offset:0 sc1 nt lds
buffer_load_dwordx4 v69, s[24:27], s54 offen offset:1088 sc1 nt lds
buffer_load_dwordx4 v70, s[24:27], s54 offen offset:2176 sc1 nt lds
buffer_load_dwordx4 v71, s[24:27], s54 offen offset:3264 sc1 nt lds
s_add_u32 m0, s38, 52224
s_add_u32 s54, s37, 16384
buffer_load_dwordx4 v72, s[28:31], s54 offen offset:0 sc1 nt lds
buffer_load_dwordx4 v73, s[28:31], s54 offen offset:1088 sc1 nt lds
buffer_load_dwordx4 v74, s[28:31], s54 offen offset:2176 sc1 nt lds
buffer_load_dwordx4 v75, s[28:31], s54 offen offset:3264 sc1 nt lds
s_add_u32 m0, s38, 69632
s_add_u32 s54, s37, 32768
buffer_load_dwordx4 v68, s[24:27], s54 offen offset:0 sc1 nt lds
buffer_load_dwordx4 v69, s[24:27], s54 offen offset:1088 sc1 nt lds
buffer_load_dwordx4 v70, s[24:27], s54 offen offset:2176 sc1 nt lds
buffer_load_dwordx4 v71, s[24:27], s54 offen offset:3264 sc1 nt lds
s_add_u32 m0, s38, 87040
s_add_u32 s54, s37, 32768
buffer_load_dwordx4 v72, s[28:31], s54 offen offset:0 sc1 nt lds
buffer_load_dwordx4 v73, s[28:31], s54 offen offset:1088 sc1 nt lds
buffer_load_dwordx4 v74, s[28:31], s54 offen offset:2176 sc1 nt lds
buffer_load_dwordx4 v75, s[28:31], s54 offen offset:3264 sc1 nt lds
s_waitcnt vmcnt(0)
v_mov_b32 v10, 0
v_mov_b32 v11, 0
v_mov_b32 v12, 0
v_mov_b32 v7, v4
v_mov_b32 v8, v5
v_mov_b32 v9, v6
s_barrier
ds_read_b128 a[48:51], v7 offset:0
ds_read_b128 a[52:55], v7 offset:64
ds_read_b128 a[56:59], v7 offset:128
ds_read_b128 a[60:63], v7 offset:192
ds_read_b128 a[64:67], v7 offset:4352
ds_read_b128 a[68:71], v7 offset:4416
ds_read_b128 a[72:75], v7 offset:4480
ds_read_b128 a[76:79], v7 offset:4544
ds_read_b128 a[80:83], v7 offset:8704
ds_read_b128 a[84:87], v7 offset:8768
ds_read_b128 a[88:91], v7 offset:8832
ds_read_b128 a[92:95], v7 offset:8896
ds_read_b128 a[96:99], v7 offset:13056
ds_read_b128 a[100:103], v7 offset:13120
ds_read_b128 a[104:107], v7 offset:13184
ds_read_b128 a[108:111], v7 offset:13248
s_waitcnt lgkmcnt(8)
v_mfma_f32_16x16x32_bf16 v[32:35], a[48:51], a[0:3], 0
v_mfma_f32_16x16x32_bf16 v[32:35], a[52:55], a[4:7], v[32:35]
v_mfma_f32_16x16x32_bf16 v[32:35], a[56:59], a[8:11], v[32:35]
v_mfma_f32_16x16x32_bf16 v[32:35], a[60:63], a[12:15], v[32:35]
v_mfma_f32_16x16x32_bf16 v[36:39], a[64:67], a[0:3], 0
v_mfma_f32_16x16x32_bf16 v[36:39], a[68:71], a[4:7], v[36:39]
v_mfma_f32_16x16x32_bf16 v[36:39], a[72:75], a[8:11], v[36:39]
v_mfma_f32_16x16x32_bf16 v[36:39], a[76:79], a[12:15], v[36:39]
s_nop 7
v_max3_f32 v28, v32, v33, v13
v_max3_f32 v29, v34, v35, v36
v_max3_f32 v28, v37, v38, v28
v_max3_f32 v28, v39, v29, v28
s_nop 0
v_mov_b32 v29, v28
s_nop 1
v_permlane16_swap_b32 v28, v29
s_nop 0
v_max_f32 v28, v28, v29
s_nop 0
v_mov_b32 v29, v28
s_nop 1
v_permlane32_swap_b32 v28, v29
s_nop 0
v_max_f32 v28, v28, v29
v_sub_f32 v32, v32, v28
v_sub_f32 v33, v33, v28
v_sub_f32 v34, v34, v28
v_sub_f32 v35, v35, v28
v_sub_f32 v36, v36, v28
v_sub_f32 v37, v37, v28
v_sub_f32 v38, v38, v28
v_sub_f32 v39, v39, v28
v_sub_f32 v16, 0, v28
v_sub_f32 v17, 0, v28
v_sub_f32 v18, 0, v28
v_sub_f32 v19, 0, v28
s_waitcnt lgkmcnt(0)
s_nop 1
v_mfma_f32_16x16x32_bf16 v[40:43], a[80:83], a[0:3], v[16:19]
v_exp_f32 v32, v32
v_mfma_f32_16x16x32_bf16 v[40:43], a[84:87], a[4:7], v[40:43]
v_exp_f32 v33, v33
v_add_f32 v10, v10, v32
v_mfma_f32_16x16x32_bf16 v[40:43], a[88:91], a[8:11], v[40:43]
v_exp_f32 v34, v34
v_mfma_f32_16x16x32_bf16 v[40:43], a[92:95], a[12:15], v[40:43]
v_add_f32 v10, v10, v33
v_cvt_pk_bf16_f32 v56, v32, v33
v_exp_f32 v35, v35
v_add_f32 v10, v10, v34
v_mfma_f32_16x16x32_bf16 v[44:47], a[96:99], a[0:3], v[16:19]
v_exp_f32 v36, v36
v_mfma_f32_16x16x32_bf16 v[44:47], a[100:103], a[4:7], v[44:47]
v_add_f32 v10, v10, v35
v_cvt_pk_bf16_f32 v57, v34, v35
v_exp_f32 v37, v37
v_add_f32 v10, v10, v36
v_mfma_f32_16x16x32_bf16 v[44:47], a[104:107], a[8:11], v[44:47]
v_exp_f32 v38, v38
v_mfma_f32_16x16x32_bf16 v[44:47], a[108:111], a[12:15], v[44:47]
v_add_f32 v10, v10, v37
v_cvt_pk_bf16_f32 v58, v36, v37
v_exp_f32 v39, v39
v_add_f32 v10, v10, v38
v_add_f32 v10, v10, v39
v_cvt_pk_bf16_f32 v59, v38, v39
s_nop 3
v_exp_f32 v40, v40
v_exp_f32 v41, v41
v_add_f32 v10, v10, v40
v_exp_f32 v42, v42
v_add_f32 v10, v10, v41
v_cvt_pk_bf16_f32 v60, v40, v41
v_exp_f32 v43, v43
v_add_f32 v10, v10, v42
v_exp_f32 v44, v44
v_add_f32 v10, v10, v43
v_cvt_pk_bf16_f32 v61, v42, v43
v_exp_f32 v45, v45
v_add_f32 v10, v10, v44
v_exp_f32 v46, v46
v_add_f32 v10, v10, v45
v_cvt_pk_bf16_f32 v62, v44, v45
v_exp_f32 v47, v47
v_add_f32 v10, v10, v46
v_add_f32 v10, v10, v47
v_cvt_pk_bf16_f32 v63, v46, v47
s_nop 1
v_mfma_f32_16x16x32_bf16 v[48:51], a[48:51], a[16:19], 0
v_mfma_f32_16x16x32_bf16 v[48:51], a[52:55], a[20:23], v[48:51]
v_mfma_f32_16x16x32_bf16 v[48:51], a[56:59], a[24:27], v[48:51]
v_mfma_f32_16x16x32_bf16 v[48:51], a[60:63], a[28:31], v[48:51]
v_mfma_f32_16x16x32_bf16 v[52:55], a[64:67], a[16:19], 0
v_mfma_f32_16x16x32_bf16 v[52:55], a[68:71], a[20:23], v[52:55]
v_mfma_f32_16x16x32_bf16 v[52:55], a[72:75], a[24:27], v[52:55]
v_mfma_f32_16x16x32_bf16 v[52:55], a[76:79], a[28:31], v[52:55]
s_barrier
ds_read_b64_tr_b16 a[112:113], v8 offset:17408
ds_read_b64_tr_b16 a[114:115], v8 offset:21760
ds_read_b64_tr_b16 a[116:117], v9 offset:17408
ds_read_b64_tr_b16 a[118:119], v9 offset:21760
ds_read_b64_tr_b16 a[120:121], v8 offset:17472
ds_read_b64_tr_b16 a[122:123], v8 offset:21824
ds_read_b64_tr_b16 a[124:125], v9 offset:17472
ds_read_b64_tr_b16 a[126:127], v9 offset:21824
ds_read_b64_tr_b16 a[128:129], v8 offset:17536
ds_read_b64_tr_b16 a[130:131], v8 offset:21888
ds_read_b64_tr_b16 a[132:133], v9 offset:17536
ds_read_b64_tr_b16 a[134:135], v9 offset:21888
ds_read_b64_tr_b16 a[136:137], v8 offset:17600
ds_read_b64_tr_b16 a[138:139], v8 offset:21952
ds_read_b64_tr_b16 a[140:141], v9 offset:17600
ds_read_b64_tr_b16 a[142:143], v9 offset:21952
s_nop 1
v_max3_f32 v28, v48, v49, v14
v_max3_f32 v29, v50, v51, v52
v_max3_f32 v28, v53, v54, v28
v_max3_f32 v28, v55, v29, v28
s_nop 0
v_mov_b32 v29, v28
s_nop 1
v_permlane16_swap_b32 v28, v29
s_nop 0
v_max_f32 v28, v28, v29
s_nop 0
v_mov_b32 v29, v28
s_nop 1
v_permlane32_swap_b32 v28, v29
s_nop 0
v_max_f32 v28, v28, v29
v_sub_f32 v48, v48, v28
v_sub_f32 v49, v49, v28
v_sub_f32 v50, v50, v28
v_sub_f32 v51, v51, v28
v_sub_f32 v52, v52, v28
v_sub_f32 v53, v53, v28
v_sub_f32 v54, v54, v28
v_sub_f32 v55, v55, v28
v_sub_f32 v20, 0, v28
v_sub_f32 v21, 0, v28
v_sub_f32 v22, 0, v28
v_sub_f32 v23, 0, v28
ds_read_b64_tr_b16 a[144:145], v8 offset:26112
ds_read_b64_tr_b16 a[146:147], v8 offset:30464
ds_read_b64_tr_b16 a[148:149], v9 offset:26112
ds_read_b64_tr_b16 a[150:151], v9 offset:30464
ds_read_b64_tr_b16 a[152:153], v8 offset:26176
ds_read_b64_tr_b16 a[154:155], v8 offset:30528
ds_read_b64_tr_b16 a[156:157], v9 offset:26176
ds_read_b64_tr_b16 a[158:159], v9 offset:30528
ds_read_b64_tr_b16 a[160:161], v8 offset:26240
ds_read_b64_tr_b16 a[162:163], v8 offset:30592
ds_read_b64_tr_b16 a[164:165], v9 offset:26240
ds_read_b64_tr_b16 a[166:167], v9 offset:30592
ds_read_b64_tr_b16 a[168:169], v8 offset:26304
ds_read_b64_tr_b16 a[170:171], v8 offset:30656
ds_read_b64_tr_b16 a[172:173], v9 offset:26304
ds_read_b64_tr_b16 a[174:175], v9 offset:30656
s_nop 1
v_mfma_f32_16x16x32_bf16 v[32:35], a[80:83], a[16:19], v[20:23]
v_exp_f32 v48, v48
v_mfma_f32_16x16x32_bf16 v[32:35], a[84:87], a[20:23], v[32:35]
v_mfma_f32_16x16x32_bf16 v[32:35], a[88:91], a[24:27], v[32:35]
v_exp_f32 v49, v49
v_mfma_f32_16x16x32_bf16 v[32:35], a[92:95], a[28:31], v[32:35]
v_add_f32 v11, v11, v48
v_mfma_f32_16x16x32_bf16 v[36:39], a[96:99], a[16:19], v[20:23]
v_exp_f32 v50, v50
v_mfma_f32_16x16x32_bf16 v[36:39], a[100:103], a[20:23], v[36:39]
v_add_f32 v11, v11, v49
v_cvt_pk_bf16_f32 v64, v48, v49
v_mfma_f32_16x16x32_bf16 v[36:39], a[104:107], a[24:27], v[36:39]
v_exp_f32 v51, v51
v_mfma_f32_16x16x32_bf16 v[36:39], a[108:111], a[28:31], v[36:39]
v_add_f32 v11, v11, v50
s_waitcnt lgkmcnt(15)
v_mfma_f32_16x16x32_bf16 v[128:131], a[112:115], v[56:59], 0
v_exp_f32 v52, v52
v_mfma_f32_16x16x32_bf16 v[132:135], a[116:119], v[56:59], 0
v_add_f32 v11, v11, v51
v_cvt_pk_bf16_f32 v65, v50, v51
v_mfma_f32_16x16x32_bf16 v[136:139], a[120:123], v[56:59], 0
v_exp_f32 v53, v53
v_mfma_f32_16x16x32_bf16 v[140:143], a[124:127], v[56:59], 0
v_add_f32 v11, v11, v52
v_mfma_f32_16x16x32_bf16 v[144:147], a[128:131], v[56:59], 0
v_exp_f32 v54, v54
v_mfma_f32_16x16x32_bf16 v[148:151], a[132:135], v[56:59], 0
v_add_f32 v11, v11, v53
v_cvt_pk_bf16_f32 v66, v52, v53
v_mfma_f32_16x16x32_bf16 v[152:155], a[136:139], v[56:59], 0
v_exp_f32 v55, v55
v_mfma_f32_16x16x32_bf16 v[156:159], a[140:143], v[56:59], 0
v_add_f32 v11, v11, v54
s_waitcnt lgkmcnt(0)
s_barrier
v_mfma_f32_16x16x32_bf16 v[128:131], a[144:147], v[60:63], v[128:131]
v_exp_f32 v32, v32
v_mfma_f32_16x16x32_bf16 v[132:135], a[148:151], v[60:63], v[132:135]
ds_read_b128 a[176:179], v7 offset:34816
ds_read_b128 a[180:183], v7 offset:34880
ds_read_b128 a[184:187], v7 offset:34944
v_add_f32 v11, v11, v55
v_cvt_pk_bf16_f32 v67, v54, v55
s_add_u32 m0, s38, 104448
s_add_u32 s54, s37, 49152
v_mfma_f32_16x16x32_bf16 v[136:139], a[152:155], v[60:63], v[136:139]
v_exp_f32 v33, v33
v_mfma_f32_16x16x32_bf16 v[140:143], a[156:159], v[60:63], v[140:143]
buffer_load_dwordx4 v68, s[24:27], s54 offen offset:0 sc1 nt lds
ds_read_b128 a[188:191], v7 offset:35008
ds_read_b128 a[192:195], v7 offset:39168
ds_read_b128 a[196:199], v7 offset:39232
v_add_f32 v11, v11, v32
v_mfma_f32_16x16x32_bf16 v[144:147], a[160:163], v[60:63], v[144:147]
v_exp_f32 v34, v34
v_mfma_f32_16x16x32_bf16 v[148:151], a[164:167], v[60:63], v[148:151]
ds_read_b128 a[200:203], v7 offset:39296
ds_read_b128 a[204:207], v7 offset:39360
v_add_f32 v11, v11, v33
v_cvt_pk_bf16_f32 v56, v32, v33
v_mfma_f32_16x16x32_bf16 v[152:155], a[168:171], v[60:63], v[152:155]
v_exp_f32 v35, v35
v_mfma_f32_16x16x32_bf16 v[156:159], a[172:175], v[60:63], v[156:159]
v_add_f32 v11, v11, v34
s_waitcnt lgkmcnt(0)
v_mfma_f32_16x16x32_bf16 v[40:43], a[176:179], a[0:3], v[16:19]
v_exp_f32 v36, v36
v_mfma_f32_16x16x32_bf16 v[40:43], a[180:183], a[4:7], v[40:43]
buffer_load_dwordx4 v69, s[24:27], s54 offen offset:1088 sc1 nt lds
ds_read_b128 a[208:211], v7 offset:43520
ds_read_b128 a[212:215], v7 offset:43584
v_add_f32 v11, v11, v35
v_cvt_pk_bf16_f32 v57, v34, v35
v_mfma_f32_16x16x32_bf16 v[40:43], a[184:187], a[8:11], v[40:43]
v_exp_f32 v37, v37
v_mfma_f32_16x16x32_bf16 v[40:43], a[188:191], a[12:15], v[40:43]
ds_read_b128 a[216:219], v7 offset:43648
ds_read_b128 a[220:223], v7 offset:43712
v_add_f32 v11, v11, v36
v_mfma_f32_16x16x32_bf16 v[44:47], a[192:195], a[0:3], v[16:19]
v_exp_f32 v38, v38
v_mfma_f32_16x16x32_bf16 v[44:47], a[196:199], a[4:7], v[44:47]
ds_read_b128 a[224:227], v7 offset:47872
ds_read_b128 a[228:231], v7 offset:47936
v_add_f32 v11, v11, v37
v_cvt_pk_bf16_f32 v58, v36, v37
v_mfma_f32_16x16x32_bf16 v[44:47], a[200:203], a[8:11], v[44:47]
v_exp_f32 v39, v39
v_mfma_f32_16x16x32_bf16 v[44:47], a[204:207], a[12:15], v[44:47]
buffer_load_dwordx4 v70, s[24:27], s54 offen offset:2176 sc1 nt lds
ds_read_b128 a[232:235], v7 offset:48000
ds_read_b128 a[236:239], v7 offset:48064
v_add_f32 v11, v11, v38
s_waitcnt lgkmcnt(0)
v_mfma_f32_16x16x32_bf16 v[48:51], a[208:211], a[0:3], v[16:19]
v_exp_f32 v40, v40
v_mfma_f32_16x16x32_bf16 v[48:51], a[212:215], a[4:7], v[48:51]
v_add_f32 v11, v11, v39
v_cvt_pk_bf16_f32 v59, v38, v39
v_mfma_f32_16x16x32_bf16 v[48:51], a[216:219], a[8:11], v[48:51]
v_exp_f32 v41, v41
v_mfma_f32_16x16x32_bf16 v[48:51], a[220:223], a[12:15], v[48:51]
buffer_load_dwordx4 v71, s[24:27], s54 offen offset:3264 sc1 nt lds
v_add_f32 v10, v10, v40
v_mfma_f32_16x16x32_bf16 v[52:55], a[224:227], a[0:3], v[16:19]
v_exp_f32 v42, v42
v_mfma_f32_16x16x32_bf16 v[52:55], a[228:231], a[4:7], v[52:55]
v_add_f32 v10, v10, v41
v_cvt_pk_bf16_f32 v60, v40, v41
v_mfma_f32_16x16x32_bf16 v[52:55], a[232:235], a[8:11], v[52:55]
v_exp_f32 v43, v43
v_mfma_f32_16x16x32_bf16 v[52:55], a[236:239], a[12:15], v[52:55]
v_add_f32 v10, v10, v42
s_add_u32 m0, s38, 121856
s_add_u32 s54, s37, 49152
v_mfma_f32_16x16x32_bf16 v[160:163], a[112:115], v[64:67], 0
v_exp_f32 v44, v44
v_mfma_f32_16x16x32_bf16 v[164:167], a[116:119], v[64:67], 0
buffer_load_dwordx4 v72, s[28:31], s54 offen offset:0 sc1 nt lds
v_add_f32 v10, v10, v43
v_cvt_pk_bf16_f32 v61, v42, v43
v_mfma_f32_16x16x32_bf16 v[168:171], a[120:123], v[64:67], 0
v_exp_f32 v45, v45
v_mfma_f32_16x16x32_bf16 v[172:175], a[124:127], v[64:67], 0
v_add_f32 v10, v10, v44
v_mfma_f32_16x16x32_bf16 v[176:179], a[128:131], v[64:67], 0
v_exp_f32 v46, v46
v_mfma_f32_16x16x32_bf16 v[180:183], a[132:135], v[64:67], 0
v_add_f32 v10, v10, v45
v_cvt_pk_bf16_f32 v62, v44, v45
v_mfma_f32_16x16x32_bf16 v[184:187], a[136:139], v[64:67], 0
v_exp_f32 v47, v47
v_mfma_f32_16x16x32_bf16 v[188:191], a[140:143], v[64:67], 0
buffer_load_dwordx4 v73, s[28:31], s54 offen offset:1088 sc1 nt lds
v_add_f32 v10, v10, v46
s_barrier
v_mfma_f32_16x16x32_bf16 v[32:35], a[176:179], a[16:19], v[20:23]
v_exp_f32 v48, v48
v_mfma_f32_16x16x32_bf16 v[32:35], a[180:183], a[20:23], v[32:35]
ds_read_b64_tr_b16 v[224:225], v8 offset:52224
ds_read_b64_tr_b16 v[226:227], v8 offset:56576
v_add_f32 v10, v10, v47
v_cvt_pk_bf16_f32 v63, v46, v47
v_mfma_f32_16x16x32_bf16 v[32:35], a[184:187], a[24:27], v[32:35]
v_exp_f32 v49, v49
v_mfma_f32_16x16x32_bf16 v[32:35], a[188:191], a[28:31], v[32:35]
ds_read_b64_tr_b16 v[228:229], v9 offset:52224
ds_read_b64_tr_b16 v[230:231], v9 offset:56576
v_add_f32 v10, v10, v48
v_mfma_f32_16x16x32_bf16 v[36:39], a[192:195], a[16:19], v[20:23]
v_exp_f32 v50, v50
v_mfma_f32_16x16x32_bf16 v[36:39], a[196:199], a[20:23], v[36:39]
buffer_load_dwordx4 v74, s[28:31], s54 offen offset:2176 sc1 nt lds
ds_read_b64_tr_b16 v[232:233], v8 offset:52288
ds_read_b64_tr_b16 v[234:235], v8 offset:56640
v_add_f32 v10, v10, v49
v_cvt_pk_bf16_f32 v64, v48, v49
v_mfma_f32_16x16x32_bf16 v[36:39], a[200:203], a[24:27], v[36:39]
v_exp_f32 v51, v51
v_mfma_f32_16x16x32_bf16 v[36:39], a[204:207], a[28:31], v[36:39]
ds_read_b64_tr_b16 v[236:237], v9 offset:52288
ds_read_b64_tr_b16 v[238:239], v9 offset:56640
v_add_f32 v10, v10, v50
v_mfma_f32_16x16x32_bf16 v[160:163], a[144:147], v[56:59], v[160:163]
v_exp_f32 v52, v52
v_mfma_f32_16x16x32_bf16 v[164:167], a[148:151], v[56:59], v[164:167]
ds_read_b64_tr_b16 v[240:241], v8 offset:52352
ds_read_b64_tr_b16 v[242:243], v8 offset:56704
v_add_f32 v10, v10, v51
v_cvt_pk_bf16_f32 v65, v50, v51
v_mfma_f32_16x16x32_bf16 v[168:171], a[152:155], v[56:59], v[168:171]
v_exp_f32 v53, v53
v_mfma_f32_16x16x32_bf16 v[172:175], a[156:159], v[56:59], v[172:175]
ds_read_b64_tr_b16 v[244:245], v9 offset:52352
ds_read_b64_tr_b16 v[246:247], v9 offset:56704
v_add_f32 v10, v10, v52
v_mfma_f32_16x16x32_bf16 v[176:179], a[160:163], v[56:59], v[176:179]
v_exp_f32 v54, v54
v_mfma_f32_16x16x32_bf16 v[180:183], a[164:167], v[56:59], v[180:183]
buffer_load_dwordx4 v75, s[28:31], s54 offen offset:3264 sc1 nt lds
ds_read_b64_tr_b16 v[248:249], v8 offset:52416
ds_read_b64_tr_b16 v[250:251], v8 offset:56768
v_add_f32 v10, v10, v53
v_cvt_pk_bf16_f32 v66, v52, v53
v_mfma_f32_16x16x32_bf16 v[184:187], a[168:171], v[56:59], v[184:187]
v_exp_f32 v55, v55
v_mfma_f32_16x16x32_bf16 v[188:191], a[172:175], v[56:59], v[188:191]
ds_read_b64_tr_b16 v[252:253], v9 offset:52416
ds_read_b64_tr_b16 v[254:255], v9 offset:56768
v_add_f32 v10, v10, v54
v_mfma_f32_16x16x32_bf16 v[40:43], a[208:211], a[16:19], v[20:23]
v_exp_f32 v32, v32
v_mfma_f32_16x16x32_bf16 v[40:43], a[212:215], a[20:23], v[40:43]
ds_read_b64_tr_b16 v[96:97], v8 offset:60928
ds_read_b64_tr_b16 v[98:99], v8 offset:65280
v_add_f32 v10, v10, v55
v_cvt_pk_bf16_f32 v67, v54, v55
v_mfma_f32_16x16x32_bf16 v[40:43], a[216:219], a[24:27], v[40:43]
v_exp_f32 v33, v33
v_mfma_f32_16x16x32_bf16 v[40:43], a[220:223], a[28:31], v[40:43]
ds_read_b64_tr_b16 v[100:101], v9 offset:60928
ds_read_b64_tr_b16 v[102:103], v9 offset:65280
v_add_f32 v11, v11, v32
s_add_u32 m0, s38, 0
s_add_u32 s54, s37, 65536
v_mfma_f32_16x16x32_bf16 v[44:47], a[224:227], a[16:19], v[20:23]
v_exp_f32 v34, v34
v_mfma_f32_16x16x32_bf16 v[44:47], a[228:231], a[20:23], v[44:47]
buffer_load_dwordx4 v68, s[24:27], s54 offen offset:0 sc1 nt lds
ds_read_b64_tr_b16 v[104:105], v8 offset:60992
ds_read_b64_tr_b16 v[106:107], v8 offset:65344
v_add_f32 v11, v11, v33
v_cvt_pk_bf16_f32 v56, v32, v33
v_mfma_f32_16x16x32_bf16 v[44:47], a[232:235], a[24:27], v[44:47]
v_exp_f32 v35, v35
v_mfma_f32_16x16x32_bf16 v[44:47], a[236:239], a[28:31], v[44:47]
ds_read_b64_tr_b16 v[108:109], v9 offset:60992
ds_read_b64_tr_b16 v[110:111], v9 offset:65344
v_add_f32 v11, v11, v34
s_waitcnt lgkmcnt(8)
v_mfma_f32_16x16x32_bf16 v[128:131], v[224:227], v[60:63], v[128:131]
v_exp_f32 v36, v36
v_mfma_f32_16x16x32_bf16 v[132:135], v[228:231], v[60:63], v[132:135]
ds_read_b64_tr_b16 v[112:113], v8 offset:61056
ds_read_b64_tr_b16 v[114:115], v8 offset:65408
v_add_f32 v11, v11, v35
v_cvt_pk_bf16_f32 v57, v34, v35
v_mfma_f32_16x16x32_bf16 v[136:139], v[232:235], v[60:63], v[136:139]
v_exp_f32 v37, v37
v_mfma_f32_16x16x32_bf16 v[140:143], v[236:239], v[60:63], v[140:143]
ds_read_b64_tr_b16 v[116:117], v9 offset:61056
ds_read_b64_tr_b16 v[118:119], v9 offset:65408
v_add_f32 v11, v11, v36
v_mfma_f32_16x16x32_bf16 v[144:147], v[240:243], v[60:63], v[144:147]
v_exp_f32 v38, v38
v_mfma_f32_16x16x32_bf16 v[148:151], v[244:247], v[60:63], v[148:151]
buffer_load_dwordx4 v69, s[24:27], s54 offen offset:1088 sc1 nt lds
ds_read_b64_tr_b16 v[120:121], v8 offset:61120
ds_read_b64_tr_b16 v[122:123], v8 offset:65472
v_add_f32 v11, v11, v37
v_cvt_pk_bf16_f32 v58, v36, v37
v_mfma_f32_16x16x32_bf16 v[152:155], v[248:251], v[60:63], v[152:155]
v_exp_f32 v39, v39
v_mfma_f32_16x16x32_bf16 v[156:159], v[252:255], v[60:63], v[156:159]
ds_read_b64_tr_b16 v[124:125], v9 offset:61120
ds_read_b64_tr_b16 v[126:127], v9 offset:65472
v_add_f32 v11, v11, v38
v_add_f32 v11, v11, v39
v_cvt_pk_bf16_f32 v59, v38, v39
s_nop 1
s_waitcnt lgkmcnt(0)
v_mfma_f32_16x16x32_bf16 v[128:131], v[96:99], v[64:67], v[128:131]
v_exp_f32 v40, v40
v_mfma_f32_16x16x32_bf16 v[132:135], v[100:103], v[64:67], v[132:135]
v_exp_f32 v41, v41
v_add_f32 v11, v11, v40
v_mfma_f32_16x16x32_bf16 v[136:139], v[104:107], v[64:67], v[136:139]
v_exp_f32 v42, v42
v_mfma_f32_16x16x32_bf16 v[140:143], v[108:111], v[64:67], v[140:143]
buffer_load_dwordx4 v70, s[24:27], s54 offen offset:2176 sc1 nt lds
v_add_f32 v11, v11, v41
v_cvt_pk_bf16_f32 v60, v40, v41
v_exp_f32 v43, v43
v_add_f32 v11, v11, v42
v_mfma_f32_16x16x32_bf16 v[144:147], v[112:115], v[64:67], v[144:147]
v_exp_f32 v44, v44
v_mfma_f32_16x16x32_bf16 v[148:151], v[116:119], v[64:67], v[148:151]
v_add_f32 v11, v11, v43
v_cvt_pk_bf16_f32 v61, v42, v43
v_exp_f32 v45, v45
v_add_f32 v11, v11, v44
v_mfma_f32_16x16x32_bf16 v[152:155], v[120:123], v[64:67], v[152:155]
v_exp_f32 v46, v46
v_mfma_f32_16x16x32_bf16 v[156:159], v[124:127], v[64:67], v[156:159]
buffer_load_dwordx4 v71, s[24:27], s54 offen offset:3264 sc1 nt lds
v_add_f32 v11, v11, v45
v_cvt_pk_bf16_f32 v62, v44, v45
v_exp_f32 v47, v47
v_add_f32 v11, v11, v46
v_add_f32 v11, v11, v47
v_cvt_pk_bf16_f32 v63, v46, v47
v_mfma_f32_16x16x32_bf16 v[160:163], v[224:227], v[56:59], v[160:163]
v_mfma_f32_16x16x32_bf16 v[164:167], v[228:231], v[56:59], v[164:167]
v_mfma_f32_16x16x32_bf16 v[168:171], v[232:235], v[56:59], v[168:171]
v_mfma_f32_16x16x32_bf16 v[172:175], v[236:239], v[56:59], v[172:175]
v_mfma_f32_16x16x32_bf16 v[176:179], v[240:243], v[56:59], v[176:179]
v_mfma_f32_16x16x32_bf16 v[180:183], v[244:247], v[56:59], v[180:183]
v_mfma_f32_16x16x32_bf16 v[184:187], v[248:251], v[56:59], v[184:187]
v_mfma_f32_16x16x32_bf16 v[188:191], v[252:255], v[56:59], v[188:191]
s_nop 1
v_mfma_f32_16x16x32_bf16 v[48:51], a[48:51], a[32:35], 0
v_mfma_f32_16x16x32_bf16 v[48:51], a[52:55], a[36:39], v[48:51]
v_mfma_f32_16x16x32_bf16 v[48:51], a[56:59], a[40:43], v[48:51]
v_mfma_f32_16x16x32_bf16 v[48:51], a[60:63], a[44:47], v[48:51]
v_mfma_f32_16x16x32_bf16 v[52:55], a[64:67], a[32:35], 0
v_mfma_f32_16x16x32_bf16 v[52:55], a[68:71], a[36:39], v[52:55]
v_mfma_f32_16x16x32_bf16 v[52:55], a[72:75], a[40:43], v[52:55]
v_mfma_f32_16x16x32_bf16 v[52:55], a[76:79], a[44:47], v[52:55]
v_mfma_f32_16x16x32_bf16 v[160:163], v[96:99], v[60:63], v[160:163]
v_mfma_f32_16x16x32_bf16 v[164:167], v[100:103], v[60:63], v[164:167]
v_mfma_f32_16x16x32_bf16 v[168:171], v[104:107], v[60:63], v[168:171]
v_mfma_f32_16x16x32_bf16 v[172:175], v[108:111], v[60:63], v[172:175]
v_mfma_f32_16x16x32_bf16 v[176:179], v[112:115], v[60:63], v[176:179]
v_mfma_f32_16x16x32_bf16 v[180:183], v[116:119], v[60:63], v[180:183]
v_mfma_f32_16x16x32_bf16 v[184:187], v[120:123], v[60:63], v[184:187]
v_mfma_f32_16x16x32_bf16 v[188:191], v[124:127], v[60:63], v[188:191]
s_add_u32 m0, s38, 17408
s_add_u32 s54, s37, 65536
buffer_load_dwordx4 v72, s[28:31], s54 offen offset:0 sc1 nt lds
v_max3_f32 v28, v48, v49, v15
v_max3_f32 v29, v50, v51, v52
v_max3_f32 v28, v53, v54, v28
v_max3_f32 v28, v55, v29, v28
s_nop 0
v_mov_b32 v29, v28
s_nop 1
v_permlane16_swap_b32 v28, v29
s_nop 0
v_max_f32 v28, v28, v29
s_nop 0
v_mov_b32 v29, v28
s_nop 1
v_permlane32_swap_b32 v28, v29
s_nop 0
v_max_f32 v28, v28, v29
v_sub_f32 v48, v48, v28
v_sub_f32 v49, v49, v28
buffer_load_dwordx4 v73, s[28:31], s54 offen offset:1088 sc1 nt lds
v_sub_f32 v50, v50, v28
v_sub_f32 v51, v51, v28
v_sub_f32 v52, v52, v28
v_sub_f32 v53, v53, v28
v_sub_f32 v54, v54, v28
v_sub_f32 v55, v55, v28
v_sub_f32 v24, 0, v28
v_sub_f32 v25, 0, v28
v_sub_f32 v26, 0, v28
v_sub_f32 v27, 0, v28
s_nop 1
v_mfma_f32_16x16x32_bf16 v[32:35], a[80:83], a[32:35], v[24:27]
v_exp_f32 v48, v48
v_mfma_f32_16x16x32_bf16 v[32:35], a[84:87], a[36:39], v[32:35]
v_exp_f32 v49, v49
v_add_f32 v12, v12, v48
v_mfma_f32_16x16x32_bf16 v[32:35], a[88:91], a[40:43], v[32:35]
v_exp_f32 v50, v50
v_mfma_f32_16x16x32_bf16 v[32:35], a[92:95], a[44:47], v[32:35]
v_add_f32 v12, v12, v49
v_cvt_pk_bf16_f32 v64, v48, v49
v_exp_f32 v51, v51
v_add_f32 v12, v12, v50
v_mfma_f32_16x16x32_bf16 v[36:39], a[96:99], a[32:35], v[24:27]
v_exp_f32 v52, v52
v_mfma_f32_16x16x32_bf16 v[36:39], a[100:103], a[36:39], v[36:39]
buffer_load_dwordx4 v74, s[28:31], s54 offen offset:2176 sc1 nt lds
v_add_f32 v12, v12, v51
v_cvt_pk_bf16_f32 v65, v50, v51
v_exp_f32 v53, v53
v_add_f32 v12, v12, v52
v_mfma_f32_16x16x32_bf16 v[36:39], a[104:107], a[40:43], v[36:39]
v_exp_f32 v54, v54
v_mfma_f32_16x16x32_bf16 v[36:39], a[108:111], a[44:47], v[36:39]
v_add_f32 v12, v12, v53
v_cvt_pk_bf16_f32 v66, v52, v53
v_exp_f32 v55, v55
v_add_f32 v12, v12, v54
v_mfma_f32_16x16x32_bf16 v[40:43], a[176:179], a[32:35], v[24:27]
v_exp_f32 v32, v32
v_mfma_f32_16x16x32_bf16 v[40:43], a[180:183], a[36:39], v[40:43]
v_add_f32 v12, v12, v55
v_cvt_pk_bf16_f32 v67, v54, v55
v_mfma_f32_16x16x32_bf16 v[40:43], a[184:187], a[40:43], v[40:43]
v_exp_f32 v33, v33
v_mfma_f32_16x16x32_bf16 v[40:43], a[188:191], a[44:47], v[40:43]
buffer_load_dwordx4 v75, s[28:31], s54 offen offset:3264 sc1 nt lds
v_add_f32 v12, v12, v32
v_mfma_f32_16x16x32_bf16 v[44:47], a[192:195], a[32:35], v[24:27]
v_exp_f32 v34, v34
v_mfma_f32_16x16x32_bf16 v[44:47], a[196:199], a[36:39], v[44:47]
v_add_f32 v12, v12, v33
v_cvt_pk_bf16_f32 v56, v32, v33
v_mfma_f32_16x16x32_bf16 v[44:47], a[200:203], a[40:43], v[44:47]
v_exp_f32 v35, v35
v_mfma_f32_16x16x32_bf16 v[44:47], a[204:207], a[44:47], v[44:47]
v_add_f32 v12, v12, v34
v_mfma_f32_16x16x32_bf16 v[192:195], a[112:115], v[64:67], 0
v_exp_f32 v36, v36
v_mfma_f32_16x16x32_bf16 v[196:199], a[116:119], v[64:67], 0
v_add_f32 v12, v12, v35
v_cvt_pk_bf16_f32 v57, v34, v35
v_mfma_f32_16x16x32_bf16 v[200:203], a[120:123], v[64:67], 0
v_exp_f32 v37, v37
v_mfma_f32_16x16x32_bf16 v[204:207], a[124:127], v[64:67], 0
v_add_f32 v12, v12, v36
v_mfma_f32_16x16x32_bf16 v[208:211], a[128:131], v[64:67], 0
v_exp_f32 v38, v38
v_mfma_f32_16x16x32_bf16 v[212:215], a[132:135], v[64:67], 0
v_add_f32 v12, v12, v37
v_cvt_pk_bf16_f32 v58, v36, v37
v_mfma_f32_16x16x32_bf16 v[216:219], a[136:139], v[64:67], 0
v_exp_f32 v39, v39
v_mfma_f32_16x16x32_bf16 v[220:223], a[140:143], v[64:67], 0
v_add_f32 v12, v12, v38
v_add_u32 v7, 69632, v4
v_add_u32 v8, 69632, v5
v_add_u32 v9, 69632, v6
s_waitcnt vmcnt(16) lgkmcnt(0)
s_barrier
s_branch L_join
L_end:
s_endpgm
.section .rodata,"a"
.p2align 6
.amdhsa_kernel standalone__gqa_softmax__near_ridge_kernel
  .amdhsa_next_free_vgpr 512
  .amdhsa_next_free_sgpr 102
  .amdhsa_accum_offset 256
  .amdhsa_group_segment_fixed_size 0
  .amdhsa_kernarg_size 48
  .amdhsa_user_sgpr_count 2
  .amdhsa_user_sgpr_kernarg_segment_ptr 1
  .amdhsa_system_sgpr_workgroup_id_x 1
.end_amdhsa_kernel
```
